```python
import torch

def _softmax(x, axis=-1):
    return torch.softmax(x, dim=axis)
def _gelu(x):
    return torch.nn.functional.gelu(x, approximate="tanh")
def _silu(x):
    return torch.nn.functional.silu(x)
def _sigmoid(x):
    return torch.sigmoid(x)
def _layernorm(x, axis=-1, eps=1e-5):
    m = x.mean(dim=axis, keepdim=True)
    v = x.var(dim=axis, keepdim=True, unbiased=False)
    return (x - m) / torch.sqrt(v + eps)
def _scatter_add(tgt, idx, src, axis=0):
    return tgt.clone().index_add_(axis, idx, src)
def _segment_sum(src, seg, n):
    out = torch.zeros((n,) + src.shape[1:], dtype=src.dtype)
    return out.index_add_(0, seg, src)
def _pad(x, pw):
    flat = tuple(v for pair in reversed(pw) for v in pair)
    return torch.nn.functional.pad(x, flat)

kernel_name = 'standalone__detection_seg_fpn_lateral__vision'

def setup_inputs():

    _w = (lambda a: (lambda t: t.to(torch.bfloat16) if t.is_floating_point() else t)(torch.as_tensor(a)))
    H = W = (224 // 2) * 2
    C = 96
    k = 5
    return {
        "c_fine": _w((lambda *s: torch.randn(*s, dtype=torch.bfloat16) * 0.05)(1, H, W, C)),
        "p_coarse": _w((lambda *s: torch.randn(*s, dtype=torch.bfloat16) * 0.05)(1, H // 2, W // 2, C)),
        "w_lat": _w((lambda *s: torch.randn(*s, dtype=torch.bfloat16) * 0.05)(C, C)),
        "w_out": _w((lambda *s: torch.randn(*s, dtype=torch.bfloat16) * 0.05)(k, k, C, C)),
    }

def reference(c_fine, p_coarse, w_lat, w_out):
    B, H, W, C = c_fine.shape
    k = 5
    lat = torch.einsum("bhwc,cd->bhwd", c_fine, w_lat)
    up = (lambda x, n, axis: torch.repeat_interleave(x, n, dim=axis))((lambda x, n, axis: torch.repeat_interleave(x, n, dim=axis))(p_coarse, 2, axis=1), 2, axis=2)
    m = lat + up
    pad = k // 2
    mp = _pad(m, ((0, 0), (pad, pad), (pad, pad), (0, 0)))
    o = None
    for di in range(k):
        for dj in range(k):
            t = torch.einsum("bhwc,cd->bhwd", mp[:, di:di + H, dj:dj + W, :], w_out[di, dj])
            o = t if o is None else o + t
    return o
```

```asm
; @launch grid=(256,1,1) block=(256,1,1) lds=163840
.amdgcn_target "amdgcn-amd-amdhsa--gfx950"
.text
.globl standalone__detection_seg_fpn_lateral__vision_kernel
.p2align 12
L_prod:
s_cmp_ge_u32 s2, 30
s_cselect_b32 s22, 2, 0
s_cmp_eq_u32 s3, 3
s_cbranch_scc1 L_p3
v_mul_u32_u24 v2, 192, v2
v_and_b32 v5, 32, v0
v_and_b32 v4, 3, v0
v_lshl_add_u32 v4, v4, 3, v5
s_lshl_b32 s27, s3, 6
v_add3_u32 v4, v4, v2, s27
s_lshl_b32 s27, s3, 1
v_lshrrev_b32 v5, 5, v0
v_add_u32 v5, s27, v5
v_mul_u32_u24 v6, 43, v5
v_lshrrev_b32 v6, 7, v6
v_mul_u32_u24 v6, 181248, v6
v_lshl_add_u32 v6, v5, 10, v6
v_and_b32 v5, 0x1f0, v1
s_mul_i32 s30, s24, 3072
s_lshl_b32 s27, s25, 9
s_add_u32 s30, s30, s27
v_add3_u32 v72, v5, v6, s30
v_add_u32 v73, 46080, v72
v_add_u32 v74, 92160, v72
v_add_u32 v75, 138240, v72
v_add_u32 v76, 368640, v72
v_add_u32 v77, 414720, v72
v_add_u32 v78, 460800, v72
v_add_u32 v79, 506880, v72
s_mov_b32 s52, 0x3fb60b61
s_mov_b32 s54, 0x3f360b61
s_mov_b32 s56, 0x3eb60b61
s_mov_b32 s58, 0x3e360b61
s_mov_b32 s60, 0x3db60b61
s_mov_b32 s72, 0xbe638e39
s_mov_b32 s74, 0xffff0000
s_cmp_lg_u32 s22, 0
s_cbranch_scc1 L_pb0
v_bfe_u32 v5, v0, 2, 2
v_lshrrev_b32 v6, 4, v0
v_cmp_eq_u32 vcc, v5, v6
v_and_b32 v5, 1, v0
v_lshlrev_b32 v5, 4, v5
v_mov_b32 v6, 0x3f80
v_lshlrev_b32 v6, v5, v6
v_cndmask_b32 v6, 0, v6, vcc
v_and_b32 v5, 2, v0
v_cmp_eq_u32 vcc, 0, v5
v_mov_b32 v106, 0
v_mov_b32 v107, 0
v_cndmask_b32 v100, 0, v6, vcc
v_sub_u32 v101, v6, v100
v_mov_b32 v102, v100
v_mov_b32 v103, v101
v_mov_b32 v104, v100
v_mov_b32 v105, v101
v_mov_b32 v30, 0
v_mov_b32 v31, 0
v_mov_b32 v42, 0
v_mov_b32 v43, 0
s_waitcnt vmcnt(0)
s_barrier
ds_read_b64_tr_b16 v[20:21], v4 offset:0
ds_read_b64_tr_b16 v[22:23], v4 offset:6144
ds_read_b64_tr_b16 v[24:25], v4 offset:3072
ds_read_b64_tr_b16 v[26:27], v4 offset:9216
ds_read_b64_tr_b16 v[28:29], v4 offset:12288
ds_read_b64_tr_b16 v[32:33], v4 offset:1536
ds_read_b64_tr_b16 v[34:35], v4 offset:7680
ds_read_b64_tr_b16 v[36:37], v4 offset:4608
ds_read_b64_tr_b16 v[38:39], v4 offset:10752
ds_read_b64_tr_b16 v[40:41], v4 offset:13824
s_waitcnt lgkmcnt(8)
v_mfma_f32_16x16x32_bf16 v[80:83], v[100:103], v[20:23], 0
s_waitcnt lgkmcnt(6)
v_mfma_f32_16x16x32_bf16 v[88:91], v[100:103], v[24:27], 0
s_waitcnt lgkmcnt(5)
v_mfma_f32_16x16x32_bf16 v[80:83], v[104:107], v[28:31], v[80:83]
s_waitcnt lgkmcnt(3)
v_mfma_f32_16x16x32_bf16 v[84:87], v[100:103], v[32:35], 0
s_waitcnt lgkmcnt(1)
v_mfma_f32_16x16x32_bf16 v[92:95], v[100:103], v[36:39], 0
s_waitcnt lgkmcnt(0)
v_mfma_f32_16x16x32_bf16 v[84:87], v[104:107], v[40:43], v[84:87]
v_pk_mul_f32 v[88:89], v[88:89], s[72:73] op_sel_hi:[1,0]
v_pk_mul_f32 v[90:91], v[90:91], s[72:73] op_sel_hi:[1,0]
s_nop 3
v_pk_mul_f32 v[92:93], v[92:93], s[72:73] op_sel_hi:[1,0]
v_pk_mul_f32 v[94:95], v[94:95], s[72:73] op_sel_hi:[1,0]
v_pk_fma_f32 v[108:109], v[80:81], s[72:73], v[88:89] op_sel_hi:[1,0,1]
v_pk_fma_f32 v[110:111], v[82:83], s[72:73], v[90:91] op_sel_hi:[1,0,1]
v_pk_fma_f32 v[112:113], v[84:85], s[72:73], v[92:93] op_sel_hi:[1,0,1]
v_pk_fma_f32 v[114:115], v[86:87], s[72:73], v[94:95] op_sel_hi:[1,0,1]
v_cvt_pk_bf16_f32 v116, v108, v109
v_cvt_pk_bf16_f32 v117, v110, v111
v_cvt_pk_bf16_f32 v118, v112, v113
v_cvt_pk_bf16_f32 v119, v114, v115
global_store_dwordx4 v72, v[116:119], s[48:49] sc1
v_pk_fma_f32 v[120:121], v[80:81], s[72:73], v[88:89] op_sel_hi:[1,0,1] neg_lo:[1,0,0] neg_hi:[1,0,0]
v_pk_fma_f32 v[122:123], v[82:83], s[72:73], v[90:91] op_sel_hi:[1,0,1] neg_lo:[1,0,0] neg_hi:[1,0,0]
v_pk_fma_f32 v[124:125], v[84:85], s[72:73], v[92:93] op_sel_hi:[1,0,1] neg_lo:[1,0,0] neg_hi:[1,0,0]
v_pk_fma_f32 v[126:127], v[86:87], s[72:73], v[94:95] op_sel_hi:[1,0,1] neg_lo:[1,0,0] neg_hi:[1,0,0]
v_cvt_pk_bf16_f32 v128, v120, v121
v_cvt_pk_bf16_f32 v129, v122, v123
v_cvt_pk_bf16_f32 v130, v124, v125
v_cvt_pk_bf16_f32 v131, v126, v127
global_store_dwordx4 v76, v[128:131], s[48:49] sc1
s_branch L_sig
L_pb0:
s_waitcnt vmcnt(0)
s_barrier
ds_read_b64_tr_b16 v[8:9], v4 offset:0
ds_read_b64_tr_b16 v[10:11], v4 offset:1536
ds_read_b64_tr_b16 v[24:25], v4 offset:12288
ds_read_b64_tr_b16 v[26:27], v4 offset:13824
ds_read_b64_tr_b16 v[16:17], v4 offset:6144
ds_read_b64_tr_b16 v[18:19], v4 offset:7680
ds_read_b64_tr_b16 v[12:13], v4 offset:3072
ds_read_b64_tr_b16 v[14:15], v4 offset:4608
ds_read_b64_tr_b16 v[20:21], v4 offset:9216
ds_read_b64_tr_b16 v[22:23], v4 offset:10752
s_waitcnt lgkmcnt(9)
v_lshlrev_b32 v32, 16, v8
v_and_b32 v33, s74, v8
v_lshlrev_b32 v34, 16, v9
v_and_b32 v35, s74, v9
s_waitcnt lgkmcnt(8)
v_lshlrev_b32 v36, 16, v10
v_and_b32 v37, s74, v10
v_lshlrev_b32 v38, 16, v11
v_and_b32 v39, s74, v11
s_waitcnt lgkmcnt(7)
v_lshlrev_b32 v64, 16, v24
v_and_b32 v65, s74, v24
v_lshlrev_b32 v66, 16, v25
v_and_b32 v67, s74, v25
s_waitcnt lgkmcnt(6)
v_lshlrev_b32 v68, 16, v26
v_and_b32 v69, s74, v26
v_lshlrev_b32 v70, 16, v27
v_and_b32 v71, s74, v27
s_waitcnt lgkmcnt(5)
v_lshlrev_b32 v48, 16, v16
v_and_b32 v49, s74, v16
v_lshlrev_b32 v50, 16, v17
v_and_b32 v51, s74, v17
s_waitcnt lgkmcnt(4)
v_lshlrev_b32 v52, 16, v18
v_and_b32 v53, s74, v18
v_lshlrev_b32 v54, 16, v19
v_and_b32 v55, s74, v19
s_waitcnt lgkmcnt(3)
v_lshlrev_b32 v40, 16, v12
v_and_b32 v41, s74, v12
v_lshlrev_b32 v42, 16, v13
v_and_b32 v43, s74, v13
s_waitcnt lgkmcnt(2)
v_lshlrev_b32 v44, 16, v14
v_and_b32 v45, s74, v14
v_lshlrev_b32 v46, 16, v15
v_and_b32 v47, s74, v15
s_waitcnt lgkmcnt(1)
v_lshlrev_b32 v56, 16, v20
v_and_b32 v57, s74, v20
v_lshlrev_b32 v58, 16, v21
v_and_b32 v59, s74, v21
s_waitcnt lgkmcnt(0)
v_lshlrev_b32 v60, 16, v22
v_and_b32 v61, s74, v22
v_lshlrev_b32 v62, 16, v23
v_and_b32 v63, s74, v23
global_store_dwordx4 v75, v[8:11], s[48:49] sc1
global_store_dwordx4 v79, v[24:27], s[48:49] sc1
v_pk_mul_f32 v[48:49], v[48:49], s[56:57] op_sel_hi:[1,0]
v_pk_mul_f32 v[50:51], v[50:51], s[56:57] op_sel_hi:[1,0]
v_pk_mul_f32 v[52:53], v[52:53], s[56:57] op_sel_hi:[1,0]
v_pk_mul_f32 v[54:55], v[54:55], s[56:57] op_sel_hi:[1,0]
v_pk_fma_f32 v[80:81], v[32:33], s[52:53], v[48:49] op_sel_hi:[1,0,1]
v_pk_fma_f32 v[82:83], v[34:35], s[52:53], v[50:51] op_sel_hi:[1,0,1]
v_pk_fma_f32 v[84:85], v[36:37], s[52:53], v[52:53] op_sel_hi:[1,0,1]
v_pk_fma_f32 v[86:87], v[38:39], s[52:53], v[54:55] op_sel_hi:[1,0,1]
v_pk_mul_f32 v[88:89], v[40:41], s[54:55] op_sel_hi:[1,0]
v_pk_mul_f32 v[90:91], v[42:43], s[54:55] op_sel_hi:[1,0]
v_pk_mul_f32 v[92:93], v[44:45], s[54:55] op_sel_hi:[1,0]
v_pk_mul_f32 v[94:95], v[46:47], s[54:55] op_sel_hi:[1,0]
v_pk_fma_f32 v[80:81], v[64:65], s[60:61], v[80:81] op_sel_hi:[1,0,1]
v_pk_fma_f32 v[82:83], v[66:67], s[60:61], v[82:83] op_sel_hi:[1,0,1]
v_pk_fma_f32 v[84:85], v[68:69], s[60:61], v[84:85] op_sel_hi:[1,0,1]
v_pk_fma_f32 v[86:87], v[70:71], s[60:61], v[86:87] op_sel_hi:[1,0,1]
v_pk_fma_f32 v[88:89], v[56:57], s[58:59], v[88:89] op_sel_hi:[1,0,1]
v_pk_fma_f32 v[90:91], v[58:59], s[58:59], v[90:91] op_sel_hi:[1,0,1]
v_pk_fma_f32 v[92:93], v[60:61], s[58:59], v[92:93] op_sel_hi:[1,0,1]
v_pk_fma_f32 v[94:95], v[62:63], s[58:59], v[94:95] op_sel_hi:[1,0,1]
v_pk_add_f32 v[96:97], v[80:81], v[88:89]
v_pk_add_f32 v[98:99], v[82:83], v[90:91]
v_pk_add_f32 v[100:101], v[84:85], v[92:93]
v_pk_add_f32 v[102:103], v[86:87], v[94:95]
v_cvt_pk_bf16_f32 v104, v96, v97
v_cvt_pk_bf16_f32 v105, v98, v99
v_cvt_pk_bf16_f32 v106, v100, v101
v_cvt_pk_bf16_f32 v107, v102, v103
global_store_dwordx4 v73, v[104:107], s[48:49] sc1
v_pk_add_f32 v[108:109], v[80:81], v[88:89] neg_lo:[0,1] neg_hi:[0,1]
v_pk_add_f32 v[110:111], v[82:83], v[90:91] neg_lo:[0,1] neg_hi:[0,1]
v_pk_add_f32 v[112:113], v[84:85], v[92:93] neg_lo:[0,1] neg_hi:[0,1]
v_pk_add_f32 v[114:115], v[86:87], v[94:95] neg_lo:[0,1] neg_hi:[0,1]
v_cvt_pk_bf16_f32 v116, v108, v109
v_cvt_pk_bf16_f32 v117, v110, v111
v_cvt_pk_bf16_f32 v118, v112, v113
v_cvt_pk_bf16_f32 v119, v114, v115
global_store_dwordx4 v74, v[116:119], s[48:49] sc1
v_pk_fma_f32 v[80:81], v[64:65], s[52:53], v[48:49] op_sel_hi:[1,0,1]
v_pk_fma_f32 v[82:83], v[66:67], s[52:53], v[50:51] op_sel_hi:[1,0,1]
v_pk_fma_f32 v[84:85], v[68:69], s[52:53], v[52:53] op_sel_hi:[1,0,1]
v_pk_fma_f32 v[86:87], v[70:71], s[52:53], v[54:55] op_sel_hi:[1,0,1]
v_pk_mul_f32 v[88:89], v[56:57], s[54:55] op_sel_hi:[1,0]
v_pk_mul_f32 v[90:91], v[58:59], s[54:55] op_sel_hi:[1,0]
v_pk_mul_f32 v[92:93], v[60:61], s[54:55] op_sel_hi:[1,0]
v_pk_mul_f32 v[94:95], v[62:63], s[54:55] op_sel_hi:[1,0]
v_pk_fma_f32 v[80:81], v[32:33], s[60:61], v[80:81] op_sel_hi:[1,0,1]
v_pk_fma_f32 v[82:83], v[34:35], s[60:61], v[82:83] op_sel_hi:[1,0,1]
v_pk_fma_f32 v[84:85], v[36:37], s[60:61], v[84:85] op_sel_hi:[1,0,1]
v_pk_fma_f32 v[86:87], v[38:39], s[60:61], v[86:87] op_sel_hi:[1,0,1]
v_pk_fma_f32 v[88:89], v[40:41], s[58:59], v[88:89] op_sel_hi:[1,0,1]
v_pk_fma_f32 v[90:91], v[42:43], s[58:59], v[90:91] op_sel_hi:[1,0,1]
v_pk_fma_f32 v[92:93], v[44:45], s[58:59], v[92:93] op_sel_hi:[1,0,1]
v_pk_fma_f32 v[94:95], v[46:47], s[58:59], v[94:95] op_sel_hi:[1,0,1]
v_pk_add_f32 v[120:121], v[80:81], v[88:89]
v_pk_add_f32 v[122:123], v[82:83], v[90:91]
v_pk_add_f32 v[124:125], v[84:85], v[92:93]
v_pk_add_f32 v[126:127], v[86:87], v[94:95]
v_cvt_pk_bf16_f32 v128, v120, v121
v_cvt_pk_bf16_f32 v129, v122, v123
v_cvt_pk_bf16_f32 v130, v124, v125
v_cvt_pk_bf16_f32 v131, v126, v127
global_store_dwordx4 v77, v[128:131], s[48:49] sc1
v_pk_add_f32 v[132:133], v[80:81], v[88:89] neg_lo:[1,0] neg_hi:[1,0]
v_pk_add_f32 v[134:135], v[82:83], v[90:91] neg_lo:[1,0] neg_hi:[1,0]
v_pk_add_f32 v[136:137], v[84:85], v[92:93] neg_lo:[1,0] neg_hi:[1,0]
v_pk_add_f32 v[138:139], v[86:87], v[94:95] neg_lo:[1,0] neg_hi:[1,0]
v_cvt_pk_bf16_f32 v140, v132, v133
v_cvt_pk_bf16_f32 v141, v134, v135
v_cvt_pk_bf16_f32 v142, v136, v137
v_cvt_pk_bf16_f32 v143, v138, v139
global_store_dwordx4 v78, v[140:143], s[48:49] sc1
L_sig:
s_waitcnt vmcnt(0)
s_barrier
s_branch L_pnext
L_p3:
s_mul_i32 s26, s22, 1024
s_lshl_b32 s27, s23, 6
s_add_u32 s26, s26, s27
s_add_u32 s26, s26, 786432
v_lshl_add_u32 v31, v0, 3, s26
s_bfm_b64 exec, 8, 0
global_store_dwordx2 v31, v[10:11], s[48:49] sc1
s_mov_b64 exec, 1
s_waitcnt vmcnt(2)
s_barrier
s_waitcnt vmcnt(0)
v_cmp_eq_u32 vcc, 0, v12
s_nop 1
v_cndmask_b32 v12, v12, v8, vcc
v_cndmask_b32 v13, v13, v9, vcc
s_barrier
global_store_dwordx2 v31, v[12:13], s[48:49] sc1
s_mov_b64 exec, -1
L_pnext:
v_min_u32 v6, 464, v1
v_lshlrev_b32 v7, 2, v6
v_lshlrev_b32 v6, 2, v6
v_and_b32 v7, 64, v7
v_add_u32 v6, 786432, v6
s_lshl2_add_u32 s26, s2, s3
s_cmp_lg_u32 s26, 120
s_cbranch_scc1 L_pl
s_mov_b64 vcc, -1
s_mov_b32 s66, 0
L_sping:
s_nop 4
s_cbranch_vccz L_spg
global_load_dwordx2 v[16:17], v7, s[46:47] offset:128 sc1
L_spg:
global_load_dwordx2 v[18:19], v6, s[48:49] offset:2048 sc1
s_add_u32 s66, s66, 1
s_waitcnt vmcnt(0)
v_cmp_ne_u64 s[82:83], v[16:17], v[18:19]
v_cmp_eq_u32 vcc, 0, v16
s_cmp_ge_u32 s66, 0x10000
s_cbranch_scc1 L_pdone
s_or_b64 s[82:83], s[82:83], vcc
s_cbranch_scc1 L_sping
v_mov_b32 v5, 1
s_mov_b64 exec, 3
global_store_dword v7, v5, s[46:47] offset:160 sc1
s_mov_b64 exec, -1
L_pl:
s_lshr_b32 s26, s2, 3
s_sub_u32 s26, s26, 4
s_cmp_ge_u32 s26, 3
s_cbranch_scc1 L_pdone
s_lshl_b32 s26, s26, 13
s_mul_i32 s27, s3, 184320
s_add_u32 s26, s26, s27
s_mov_b64 s[16:17], s[48:49]
s_add_u32 s18, s27, 46080
s_mov_b32 s19, 0x20000
v_lshlrev_b32 v4, 3, v1
s_mov_b32 s28, s26
s_cmp_lg_u32 s3, 3
s_cbranch_scc1 L_paa
s_mov_b64 vcc, -1
s_waitcnt vmcnt(0)
s_mov_b32 s66, 0
L_spina:
s_nop 4
s_cbranch_vccz L_spa
global_load_dwordx2 v[16:17], v7, s[46:47] offset:0 sc1
L_spa:
global_load_dwordx2 v[18:19], v6, s[48:49] offset:0 sc1
s_add_u32 s66, s66, 1
s_waitcnt vmcnt(0)
v_cmp_ne_u64 s[82:83], v[16:17], v[18:19]
v_cmp_eq_u32 vcc, 0, v16
s_cmp_ge_u32 s66, 0x10000
s_cbranch_scc1 L_paa
s_or_b64 s[82:83], s[82:83], vcc
s_cbranch_scc1 L_spina
L_paa:
s_barrier
buffer_load_dword v8, v4, s[16:19], s28 offen sc1
s_add_u32 s28, s28, 24576
buffer_load_dword v9, v4, s[16:19], s28 offen sc1
s_add_u32 s28, s28, 24576
s_waitcnt vmcnt(1)
s_cmp_lg_u32 s3, 3
s_cbranch_scc1 L_pab
s_mov_b64 vcc, -1
s_mov_b32 s66, 0
L_spinb:
global_load_dword v16, v7, s[46:47] offset:160 sc1
s_add_u32 s66, s66, 1
s_waitcnt vmcnt(0)
v_cmp_eq_u32 vcc, 0, v16
s_cmp_ge_u32 s66, 0x10000
s_cbranch_scc1 L_pab
s_cmp_lg_u64 vcc, 0
s_cbranch_scc1 L_spinb
L_pab:
s_barrier
s_add_u32 s18, s27, 184320
s_add_u32 s28, s26, 46080
buffer_load_dword v32, v4, s[16:19], s28 offen sc1
s_add_u32 s28, s28, 24576
buffer_load_dword v33, v4, s[16:19], s28 offen sc1
s_add_u32 s28, s28, 24576
buffer_load_dword v34, v4, s[16:19], s28 offen sc1
s_add_u32 s28, s28, 24576
buffer_load_dword v35, v4, s[16:19], s28 offen sc1
s_add_u32 s28, s28, 24576
buffer_load_dword v36, v4, s[16:19], s28 offen sc1
s_add_u32 s28, s28, 24576
buffer_load_dword v37, v4, s[16:19], s28 offen sc1
s_add_u32 s28, s28, 24576
L_plw:
s_waitcnt vmcnt(0)
L_pdone:
L_end2:
s_endpgm
L_pend:
.fill (3328-(L_pend-L_prod))/4, 4, 0xbf810000
.p2align 8
.type standalone__detection_seg_fpn_lateral__vision_kernel,@function
standalone__detection_seg_fpn_lateral__vision_kernel:
s_load_dwordx8 s[36:43], s[0:1], 0
s_load_dwordx4 s[44:47], s[0:1], 32
s_load_dwordx2 s[48:49], s[0:1], 48
v_lshrrev_b32 v3, 6, v0
v_and_b32 v0, 63, v0
v_lshlrev_b32 v1, 4, v0
v_readfirstlane_b32 s3, v3
s_cmp_ge_u32 s2, 60
s_cbranch_scc1 L_cons
s_mov_b32 s23, s2
s_cmp_lt_u32 s2, 30
s_cbranch_scc1 L_ph
s_sub_u32 s23, s2, 30
s_getpc_b64 s[4:5]
L_pc:
s_lshr_b32 s31, s2, 3
s_lshl2_add_u32 s31, s31, s3
s_sub_u32 s31, s31, 16
s_lshl_b32 s31, s31, 11
v_and_b32 v7, 15, v0
v_lshl_add_u32 v7, v7, 7, s31
v_min_u32 v7, L_end-L_pc-4, v7
v_mov_b32 v9, s5
v_add_co_u32 v8, vcc, s4, v7
s_nop 1
v_addc_co_u32 v9, vcc, 0, v9, vcc
global_load_dword v3, v[8:9], off
L_ph:
s_lshr_b32 s24, s23, 1
s_and_b32 s25, s23, 1
s_mul_i32 s27, s24, 103
s_lshr_b32 s27, s27, 9
s_mul_i32 s28, s24, 92160
s_mul_i32 s27, s27, 454656
s_sub_u32 s28, s28, s27
s_mul_i32 s27, s25, 1536
s_add_u32 s28, s28, s27
s_mul_i32 s27, s3, 18432
s_add_u32 s27, s27, s28
v_add_u32 v72, s27, v1
v_add_u32 v74, 1536, v72
v_and_b32 v2, 32, v0
v_mad_u32_u24 v73, v2, 48, v72
s_min_u32 s26, s3, 2
s_lshl_b32 s26, s26, 10
v_add_u32 v4, s26, v1
v_lshrrev_b32 v2, 9, v4
v_mul_u32_u24 v2, 43, v2
v_lshrrev_b32 v2, 7, v2
v_mul_u32_u24 v2, 1536, v2
s_add_u32 s28, s28, 73728
v_add3_u32 v75, v4, v2, s28
s_mul_i32 m0, s3, 3072
s_waitcnt lgkmcnt(0)
global_load_lds_dwordx4 v72, s[42:43] offset:0
global_load_lds_dwordx4 v73, s[42:43] offset:1024
global_load_lds_dwordx4 v74, s[42:43] offset:2048
s_add_u32 m0, s26, 12288
v_bfe_u32 v2, v0, 2, 3
global_load_lds_dwordx4 v75, s[42:43]
s_cmp_lg_u32 s3, 3
s_cbranch_scc1 L_prod
s_memrealtime s[20:21]
s_cmp_ge_u32 s2, 30
s_cselect_b32 s22, 2, 0
s_add_u32 s26, s22, s25
s_lshl_b32 s26, s26, 6
v_mov_b32 v30, s26
v_mov_b32 v10, 0
v_mov_b32 v11, 0
s_waitcnt lgkmcnt(0)
s_or_b32 s20, s20, 1
v_mov_b32 v8, s20
v_mov_b32 v9, s21
s_mov_b64 exec, 1
global_atomic_cmpswap_x2 v[12:13], v30, v[8:11], s[46:47] sc0 sc1
s_mov_b64 exec, -1
s_branch L_p3
L_cons:
s_cmp_ge_u32 s2, 256
s_cbranch_scc1 L_end2
s_lshr_b32 s27, s2, 3
s_bitcmp1_b32 s2, 2
s_cselect_b32 s26, 17, -8
s_add_u32 s27, s27, s26
s_mul_i32 s26, s27, 37
s_lshr_b32 s26, s26, 8
s_and_b32 s28, s2, 1
s_sub_u32 s28, s28, s26
s_mul_i32 s28, s28, 7
s_add_u32 s30, s28, s27
s_bfe_u32 s28, s2, 0x10001
s_mul_i32 s28, s28, 7
s_add_u32 s31, s28, s26
s_mul_i32 s25, s30, 3072
s_lshl_b32 s24, s31, 4
s_and_b32 s27, s3, 2
s_lshl2_add_u32 s26, s3, s24
s_add_u32 s63, s26, s27
s_add_u32 s63, s63, 2
s_sub_u32 s20, s26, s27
s_add_u32 s20, s20, 4
s_lshl3_add_u32 s21, s27, s3
s_add_u32 s21, s21, s24
s_mul_i32 s62, s63, 43008
s_add_u32 s62, s62, s25
s_brev_b32 s34, 2
s_cmp_lt_u32 s21, 2
s_cselect_b32 s35, s34, 0
s_mul_i32 s58, s3, 25152
s_add_u32 s58, s58, 62464
s_mov_b32 s6, 9720192
s_mov_b32 s7, 0x20000
s_and_b32 s60, s3, 1
v_mov_b32 v21, v1
v_xor_b32 v8, 32, v1
v_and_b32 v3, 32, v0
v_xor_b32 v7, v3, v1
s_mul_i32 s28, s3, 3072
s_mov_b32 s14, 18432
s_mov_b32 s15, s7
s_lshl_b32 s27, s60, 5
v_xor_b32 v9, s27, v1
s_lshr_b32 s29, s28, 1
s_add_u32 s29, s29, 12288
s_cmp_eq_u32 s30, 13
s_cselect_b32 s33, s34, 0
s_add_u32 s51, s62, 43008
s_mul_i32 s52, s20, 43008
s_add_u32 s52, s52, s25
s_add_u32 s53, s52, 43008
s_mul_i32 s54, s21, 43008
s_add_u32 s54, s54, s25
s_add_u32 s54, s54, s35
s_movk_i32 s59, 3072
s_add_u32 s64, s59, s33
s_add_u32 s65, s62, 3072
v_and_b32 v11, 0xf0, v1
v_add_u32 v10, s54, v11
v_or_b32 v15, s33, v1
s_bfm_b64 exec, 48, 0
v_add_u32 v10, s53, v11
s_bfm_b64 exec, 32, 0
v_add_u32 v10, s52, v11
s_bfm_b64 exec, 24, 0
v_mov_b32 v15, v1
s_bfm_b64 exec, 16, 0
v_add_u32 v10, s51, v11
s_mov_b64 exec, -1
s_lshr_b32 s27, s33, 27
v_and_b32 v11, s27, v0
v_lshl_or_b32 v11, v11, 27, v10
s_mov_b32 m0, s28
s_waitcnt lgkmcnt(0)
s_mov_b64 s[12:13], s[40:41]
buffer_load_dwordx4 v21, s[12:15], s28 offen offset:0  lds
buffer_load_dwordx4 v7, s[12:15], s28 offen offset:1024  lds
buffer_load_dwordx4 v8, s[12:15], s28 offen offset:2048  lds
s_mov_b32 m0, s29
s_nop 0
buffer_load_dwordx4 v9, s[12:15], s29 offen offset:0  lds
s_bfm_b64 exec, 32, 0
buffer_load_dwordx4 v9, s[12:15], s29 offen offset:1024  lds
s_mov_b64 exec, -1
s_add_u32 m0, s58, 21120
s_sub_u32 s4, s36, 86400
s_subb_u32 s5, s37, 0
buffer_load_dwordx4 v10, s[4:7], s59 offen offset:0  lds
s_add_u32 m0, s58, 21888
s_nop 0
buffer_load_dwordx4 v11, s[4:7], s59 offen offset:256  lds
s_add_u32 m0, s58, 22656
s_nop 0
buffer_load_dwordx4 v10, s[4:7], s64 offen offset:512  lds
s_add_u32 m0, s58, 24320
s_bfm_b64 exec, 48, 0
buffer_load_dwordx4 v15, s[4:7], s65 offen offset:0  lds
s_mov_b64 exec, -1
s_cmp_eq_u32 s30, 0
s_cselect_b32 s32, s34, 0
v_mov_b32 v6, v1
s_bfm_b64 exec, 24, 0
v_or_b32 v6, s32, v1
s_mov_b64 exec, -1
s_mov_b32 s50, s62
s_add_u32 m0, s58, 0
s_nop 0
buffer_load_dwordx4 v6, s[4:7], s50 offen offset:0  lds
buffer_load_dwordx4 v7, s[4:7], s50 offen offset:1024  lds
s_lshr_b32 s27, s25, 1
s_mul_i32 s55, s63, 10752
s_add_u32 s55, s55, s27
s_mul_i32 s56, s20, 10752
s_add_u32 s56, s56, s27
s_lshr_b32 s57, s21, 1
s_mul_i32 s57, s57, 21504
s_add_u32 s57, s57, s27
s_add_u32 s57, s57, s35
v_mov_b32 v12, v1
v_or_b32 v13, s33, v1
s_mov_b32 s10, 2430144
s_mov_b32 s11, s7
s_bfm_b64 exec, 44, 0
v_mov_b32 v13, v1
s_bfm_b64 exec, 12, 0
v_or_b32 v12, s32, v1
s_mov_b64 exec, -1
s_sub_u32 s8, s38, 21696
s_subb_u32 s9, s39, 0
v_and_b32 v4, 15, v0
v_lshrrev_b32 v5, 4, v0
v_lshl_add_u32 v20, v5, 4, s58
s_movk_i32 s26, 192
v_and_b32 v16, 3, v0
v_and_b32 v22, 8, v4
v_lshlrev_b32 v22, 2, v22
v_xor_b32 v22, v22, v20
v_mad_u32_u24 v14, v4, s26, v22
v_mad_u32_u24 v35, v16, s26, v20
v_bfe_u32 v17, v0, 2, 2
v_lshl_add_u32 v22, v17, 8, v35
v_mul_u32_u24 v23, 3, v16
s_movk_i32 s27, 768
v_add_u32 v38, 0, v23
v_lshrrev_b32 v38, 2, v38
v_mad_u32_u24 v32, v38, s27, v22
v_add_u32 v38, 1, v23
v_lshrrev_b32 v38, 2, v38
v_mad_u32_u24 v33, v38, s27, v22
v_add_u32 v38, 2, v23
v_lshrrev_b32 v38, 2, v38
v_mad_u32_u24 v34, v38, s27, v22
s_movk_i32 s27, 200
v_lshl_add_u32 v22, v5, 3, s58
v_mad_u32_u24 v36, v4, s27, v22
v_mad_u32_u24 v37, v16, s27, v22
v_lshlrev_b32 v16, 3, v16
v_lshl_add_u32 v20, v5, 3, v17
v_mad_u32_u24 v20, v20, s26, v16
v_and_b32 v23, 1, v5
v_lshlrev_b32 v22, 5, v23
v_add_u32 v18, v20, v22
v_sub_u32 v19, v20, v22
v_lshrrev_b32 v22, 2, v0
v_min_u32 v22, 9, v22
v_mad_u32_u24 v20, v22, s26, v16
v_mad_u32_u24 v22, v17, s27, v16
s_add_u32 s27, s58, 15360
s_mul_i32 s26, s60, 0
v_add_u32 v64, s27, v20
v_add_u32 v65, s26, v64
v_add_u32 v66, 1920, v64
v_add_u32 v67, 1920, v65
v_add_u32 v68, 3840, v64
s_add_u32 s27, s58, 21120
s_bfm_b64 exec, 16, 48
v_add_u32 v64, s27, v22
v_add_u32 v65, 0, v64
v_add_u32 v66, 800, v64
v_add_u32 v67, 1600, v64
v_add_u32 v68, 2400, v64
s_mov_b64 exec, -1
v_mul_u32_u24 v20, 15616, v23
v_lshrrev_b32 v22, 1, v5
v_mul_u32_u24 v22, 320, v22
v_add_u32 v20, v20, v22
s_mul_i32 s26, s60, 7744
v_lshl_add_u32 v2, v4, 4, v20
v_add_u32 v2, s26, v2
v_and_b32 v16, 3, v0
v_sub_u32 v22, v5, v16
v_add_u32 v23, v22, v5
v_cmp_eq_u32 s[66:67], 0, v22
v_cmp_eq_u32 s[68:69], 1, v22
v_cmp_eq_u32 s[70:71], -1, v23
v_cmp_eq_u32 s[72:73], 0, v23
v_cmp_eq_u32 s[74:75], 1, v23
v_mov_b32 v88, 0x3f800000
v_mov_b32 v89, 0xc0883f80
v_mov_b32 v90, 0x3f80c088
v_mov_b32 v91, 0x3f80
v_mov_b32 v92, 0xc0503f80
v_mov_b32 v93, 0x3f80c050
v_mov_b32 v94, 0xbf800000
v_mov_b32 v95, 0x3fa04000
v_mov_b32 v96, 0xbe80c020
v_mov_b32 v97, 0x3f00
v_mov_b32 v98, 0x4050bf80
v_mov_b32 v99, 0x3f00c030
s_mov_b32 exec_lo, 0xfff0fff0
s_mov_b32 exec_hi, exec_lo
v_mov_b32 v88, 0xbf800000
v_mov_b32 v89, 0x40883f80
v_mov_b32 v90, 0xbf80c088
v_mov_b32 v92, 0x40a8bf80
v_mov_b32 v93, 0x3f80c0a8
v_mov_b32 v94, 0xbf000000
v_mov_b32 v95, 0x40203e80
v_mov_b32 v96, 0xc000bfa0
v_mov_b32 v97, 0x3f80
v_mov_b32 v98, 0x4030bf00
v_mov_b32 v99, 0x3f80c050
s_mov_b32 exec_lo, 0xff00ff00
s_mov_b32 exec_hi, exec_lo
v_mov_b32 v88, 0x3f800000
v_mov_b32 v89, 0xbfa04000
v_mov_b32 v90, 0x3e80c020
v_mov_b32 v91, 0x3f00
v_mov_b32 v92, 0x3f403f80
v_mov_b32 v93, 0x3f00c010
v_mov_b32 v94, 0x3f80
v_mov_b32 v95, 0xc0a8
v_mov_b32 v96, 0x40a8
v_mov_b32 v97, 0xbf80
v_mov_b32 v98, 0xc0a83f80
v_mov_b32 v99, 0xbf8040a8
s_mov_b32 exec_lo, 0xf000f000
s_mov_b32 exec_hi, exec_lo
v_mov_b32 v88, 0x3f000000
v_mov_b32 v89, 0xc0203e80
v_mov_b32 v90, 0x4000bfa0
v_mov_b32 v91, 0x3f80
v_mov_b32 v92, 0xc0103f00
v_mov_b32 v93, 0x3f803f40
v_mov_b32 v94, 0xbf800000
v_mov_b32 v95, 0x40a80000
v_mov_b32 v96, 0xc0a80000
v_mov_b32 v97, 0x3f800000
v_mov_b32 v98, 0x40a8bf80
v_mov_b32 v99, 0x3f80c0a8
s_mov_b64 exec, -1
v_cndmask_b32 v24, 0, v88, s[66:67]
v_cndmask_b32 v24, v24, v90, s[68:69]
v_cndmask_b32 v26, 0, v92, s[72:73]
v_cndmask_b32 v26, v26, v93, s[74:75]
v_cndmask_b32 v25, 0, v89, s[66:67]
v_cndmask_b32 v25, v25, v91, s[68:69]
v_cndmask_b32 v27, 0, v92, s[70:71]
v_cndmask_b32 v27, v27, v93, s[72:73]
v_cndmask_b32 v28, 0, v94, s[66:67]
v_cndmask_b32 v28, v28, v96, s[68:69]
v_cndmask_b32 v30, 0, v98, s[72:73]
v_cndmask_b32 v30, v30, v99, s[74:75]
v_cndmask_b32 v29, 0, v95, s[66:67]
v_cndmask_b32 v29, v29, v97, s[68:69]
v_cndmask_b32 v31, 0, v98, s[70:71]
v_cndmask_b32 v31, v31, v99, s[72:73]
s_mov_b32 exec_lo, 0
s_mov_b32 exec_hi, 0x88880000
v_mov_b32 v26, v90
v_mov_b32 v27, v91
v_mov_b32 v30, v96
v_mov_b32 v31, v97
s_mov_b64 exec, -1
v_and_b32 v22, 7, v4
v_mul_u32_u24 v22, 1936, v22
s_sub_u32 s26, s63, s24
s_lshl_b32 s26, s26, 4
v_add3_u32 v20, v20, v22, s26
v_lshrrev_b32 v22, 3, v4
v_mul_u32_u24 v22, 31232, v22
v_sub_u32 v0, v20, v22
v_add_u32 v0, 31232, v0
v_add_u32 v3, v20, v22
v_add_u32 v3, 101376, v3
s_sub_u32 s26, s20, s63
s_lshl_b32 s26, s26, 4
s_sub_u32 s27, s21, s63
s_lshl_b32 s27, s27, 4
v_add_u32 v192, s26, v0
v_add_u32 v193, s27, v0
v_add_u32 v194, s26, v3
v_add_u32 v195, s27, v3
s_lshr_b32 s26, s3, 1
s_lshl1_add_u32 s26, s60, s26
s_mul_i32 s26, s26, 184320
s_add_u32 s26, s26, 4096
v_min_u32 v70, 464, v1
v_lshlrev_b32 v69, 2, v70
v_lshlrev_b32 v70, 2, v70
v_and_b32 v69, 64, v69
v_add_u32 v70, 786432, v70
v_add_u32 v1, s26, v1
buffer_load_dwordx4 v8, s[4:7], s50 offen offset:2048  lds
s_add_u32 m0, s58, 15360
s_nop 0
buffer_load_dwordx4 v12, s[8:11], s55 offen offset:0  lds
s_waitcnt vmcnt(8)
s_barrier
ds_read_b64_tr_b16 a[0:1], v18 offset:0
ds_read_b64_tr_b16 a[2:3], v18 offset:768
ds_read_b64_tr_b16 a[4:5], v18 offset:6144
ds_read_b64_tr_b16 a[6:7], v18 offset:6912
s_bfm_b64 exec, 56, 0
buffer_load_dwordx4 v13, s[8:11], s55 offen offset:1024  lds
s_mov_b64 exec, -1
ds_read_b64_tr_b16 a[8:9], v18 offset:12288
ds_read_b64_tr_b16 a[10:11], v18 offset:13056
ds_read_b64_tr_b16 a[12:13], v19 offset:32
ds_read_b64_tr_b16 a[14:15], v19 offset:800
ds_read_b64_tr_b16 a[16:17], v19 offset:6176
ds_read_b64_tr_b16 a[18:19], v19 offset:6944
s_add_u32 m0, s58, 3072
s_nop 0
buffer_load_dwordx4 v6, s[4:7], s51 offen offset:0  lds
ds_read_b64_tr_b16 a[20:21], v19 offset:12320
ds_read_b64_tr_b16 a[22:23], v19 offset:13088
ds_read_b64_tr_b16 a[24:25], v18 offset:64
ds_read_b64_tr_b16 a[26:27], v18 offset:832
ds_read_b64_tr_b16 a[28:29], v18 offset:6208
ds_read_b64_tr_b16 a[30:31], v18 offset:6976
buffer_load_dwordx4 v7, s[4:7], s51 offen offset:1024  lds
ds_read_b64_tr_b16 a[32:33], v18 offset:12352
ds_read_b64_tr_b16 a[34:35], v18 offset:13120
ds_read_b64_tr_b16 a[36:37], v19 offset:96
ds_read_b64_tr_b16 a[38:39], v19 offset:864
ds_read_b64_tr_b16 a[40:41], v19 offset:6240
ds_read_b64_tr_b16 a[42:43], v19 offset:7008
ds_read_b64_tr_b16 a[44:45], v19 offset:12384
ds_read_b64_tr_b16 a[46:47], v19 offset:13152
ds_read_b64_tr_b16 a[48:49], v18 offset:128
ds_read_b64_tr_b16 a[50:51], v18 offset:896
ds_read_b64_tr_b16 a[52:53], v18 offset:6272
s_mov_b64 exec, 0
s_cmp_eq_u32 s3, 0
s_cbranch_scc1 L_stub0
s_cmp_eq_u32 s3, 1
s_cbranch_scc1 L_stub1
s_cmp_eq_u32 s3, 2
s_cbranch_scc1 L_stub2
s_branch L_stub3
L_body:
s_mov_b64 exec, -1
s_waitcnt vmcnt(7)
ds_read_b128 a[84:87], v32 offset:21120
ds_read_b128 a[88:91], v33 offset:21184
ds_read_b128 a[92:95], v34 offset:21248
buffer_load_dwordx4 v8, s[4:7], s51 offen offset:2048  lds
s_add_u32 m0, s58, 6144
s_nop 0
buffer_load_dwordx4 v6, s[4:7], s52 offen offset:0  lds
ds_read_b64_tr_b16 a[54:55], v18 offset:7040
ds_read_b64_tr_b16 a[56:57], v18 offset:12416
ds_read_b64_tr_b16 a[58:59], v18 offset:13184
ds_read_b64_tr_b16 a[60:61], v19 offset:160
ds_read_b64_tr_b16 a[62:63], v19 offset:928
s_waitcnt lgkmcnt(7)
v_mfma_f32_16x16x32_bf16 v[72:75], a[0:3], a[84:87], 0
s_waitcnt lgkmcnt(6)
ds_read_b64_tr_b16 a[64:65], v19 offset:6304
v_mfma_f32_16x16x32_bf16 v[72:75], a[4:7], a[88:91], v[72:75]
s_waitcnt lgkmcnt(6)
ds_read_b64_tr_b16 a[66:67], v19 offset:7072
v_mfma_f32_16x16x32_bf16 v[72:75], a[8:11], a[92:95], v[72:75]
ds_read_b64_tr_b16 a[68:69], v19 offset:12448
s_nop 0
v_mfma_f32_16x16x32_bf16 v[76:79], a[12:15], a[84:87], 0
ds_read_b64_tr_b16 a[70:71], v19 offset:13216
s_nop 0
v_mfma_f32_16x16x32_bf16 v[76:79], a[16:19], a[88:91], v[76:79]
ds_read_b128 a[96:99], v35 offset:24320
v_mfma_f32_16x16x32_bf16 v[76:79], a[20:23], a[92:95], v[76:79]
ds_read_b128 a[100:103], v35 offset:24384
v_cvt_pk_bf16_f32 v130, v72, v73
v_mfma_f32_16x16x32_bf16 v[80:83], a[24:27], a[84:87], 0
ds_read_b128 a[104:107], v35 offset:24448
v_cvt_pk_bf16_f32 v131, v74, v75
v_mfma_f32_16x16x32_bf16 v[80:83], a[28:31], a[88:91], v[80:83]
ds_write_b64 v36, v[130:131] offset:21120
v_mfma_f32_16x16x32_bf16 v[80:83], a[32:35], a[92:95], v[80:83]
buffer_load_dwordx4 v7, s[4:7], s52 offen offset:1024  lds
v_mfma_f32_16x16x32_bf16 v[84:87], a[36:39], a[84:87], 0
buffer_load_dwordx4 v8, s[4:7], s52 offen offset:2048  lds
v_mfma_f32_16x16x32_bf16 v[84:87], a[40:43], a[88:91], v[84:87]
v_cvt_pk_bf16_f32 v132, v76, v77
v_cvt_pk_bf16_f32 v133, v78, v79
v_mfma_f32_16x16x32_bf16 v[84:87], a[44:47], a[92:95], v[84:87]
ds_write_b64 v36, v[132:133] offset:21152
v_mfma_f32_16x16x32_bf16 v[72:75], a[48:51], a[84:87], 0
s_waitcnt lgkmcnt(13)
v_cvt_pk_bf16_f32 v134, v80, v81
v_cvt_pk_bf16_f32 v135, v82, v83
v_mfma_f32_16x16x32_bf16 v[72:75], a[52:55], a[88:91], v[72:75]
s_waitcnt lgkmcnt(11)
ds_write_b64 v36, v[134:135] offset:21184
v_mfma_f32_16x16x32_bf16 v[72:75], a[56:59], a[92:95], v[72:75]
s_waitcnt lgkmcnt(10)
v_cvt_pk_bf16_f32 v128, v84, v85
v_cvt_pk_bf16_f32 v129, v86, v87
v_mfma_f32_16x16x32_bf16 v[76:79], a[60:63], a[84:87], 0
s_waitcnt lgkmcnt(8)
ds_write_b64 v36, v[128:129] offset:21216
v_mfma_f32_16x16x32_bf16 v[76:79], a[64:67], a[88:91], v[76:79]
s_waitcnt lgkmcnt(7)
v_cvt_pk_bf16_f32 v130, v72, v73
v_cvt_pk_bf16_f32 v131, v74, v75
v_mfma_f32_16x16x32_bf16 v[76:79], a[68:71], a[92:95], v[76:79]
s_waitcnt lgkmcnt(6)
ds_write_b64 v36, v[130:131] offset:21248
v_mfma_f32_16x16x32_bf16 v[80:83], a[96:99], a[0:3], 0
s_waitcnt lgkmcnt(6)
s_nop 1
v_mfma_f32_16x16x32_bf16 v[80:83], a[100:103], a[4:7], v[80:83]
s_waitcnt lgkmcnt(5)
v_cvt_pk_bf16_f32 v132, v76, v77
v_cvt_pk_bf16_f32 v133, v78, v79
v_mfma_f32_16x16x32_bf16 v[80:83], a[104:107], a[8:11], v[80:83]
s_barrier
ds_write_b64 v36, v[132:133] offset:21280
v_mfma_f32_16x16x32_bf16 v[84:87], a[96:99], a[12:15], 0
s_nop 2
v_mfma_f32_16x16x32_bf16 v[84:87], a[100:103], a[16:19], v[84:87]
v_mfma_f32_16x16x32_bf16 v[84:87], a[104:107], a[20:23], v[84:87]
v_cvt_pk_bf16_f32 v164, v80, v81
v_cvt_pk_bf16_f32 v165, v82, v83
v_mfma_f32_16x16x32_bf16 v[72:75], a[96:99], a[24:27], 0
s_nop 2
v_mfma_f32_16x16x32_bf16 v[72:75], a[100:103], a[28:31], v[72:75]
v_mfma_f32_16x16x32_bf16 v[72:75], a[104:107], a[32:35], v[72:75]
v_cvt_pk_bf16_f32 v166, v84, v85
v_cvt_pk_bf16_f32 v167, v86, v87
v_mfma_f32_16x16x32_bf16 v[76:79], a[96:99], a[36:39], 0
s_nop 2
v_mfma_f32_16x16x32_bf16 v[76:79], a[100:103], a[40:43], v[76:79]
v_mfma_f32_16x16x32_bf16 v[76:79], a[104:107], a[44:47], v[76:79]
s_waitcnt vmcnt(8)
ds_read_b128 a[72:75], v14 offset:0
v_cvt_pk_bf16_f32 v168, v72, v73
v_mfma_f32_16x16x32_bf16 v[80:83], a[96:99], a[48:51], 0
ds_read_b128 a[76:79], v14 offset:64
v_cvt_pk_bf16_f32 v169, v74, v75
v_mfma_f32_16x16x32_bf16 v[80:83], a[100:103], a[52:55], v[80:83]
ds_read_b128 a[80:83], v14 offset:128
v_cvt_pk_bf16_f32 v170, v76, v77
v_mfma_f32_16x16x32_bf16 v[80:83], a[104:107], a[56:59], v[80:83]
s_add_u32 m0, s58, 17280
v_cvt_pk_bf16_f32 v171, v78, v79
s_nop 0
v_mfma_f32_16x16x32_bf16 v[84:87], a[96:99], a[60:63], 0
buffer_load_dwordx4 v12, s[8:11], s56 offen offset:0  lds
v_mfma_f32_16x16x32_bf16 v[84:87], a[100:103], a[64:67], v[84:87]
s_bfm_b64 exec, 56, 0
buffer_load_dwordx4 v13, s[8:11], s56 offen offset:1024  lds
s_mov_b64 exec, -1
v_mfma_f32_16x16x32_bf16 v[84:87], a[104:107], a[68:71], v[84:87]
s_waitcnt lgkmcnt(2)
v_cvt_pk_bf16_f32 v172, v80, v81
v_cvt_pk_bf16_f32 v173, v82, v83
v_mfma_f32_16x16x32_bf16 v[72:75], a[72:75], a[0:3], 0
s_waitcnt lgkmcnt(1)
s_add_u32 m0, s58, 9216
s_nop 0
v_mfma_f32_16x16x32_bf16 v[72:75], a[76:79], a[4:7], v[72:75]
s_waitcnt lgkmcnt(0)
buffer_load_dwordx4 v6, s[4:7], s53 offen offset:0  lds
v_mfma_f32_16x16x32_bf16 v[72:75], a[80:83], a[8:11], v[72:75]
v_cvt_pk_bf16_f32 v174, v84, v85
v_cvt_pk_bf16_f32 v175, v86, v87
v_mfma_f32_16x16x32_bf16 v[76:79], a[72:75], a[12:15], 0
s_waitcnt vmcnt(9)
buffer_load_dwordx4 v7, s[4:7], s53 offen offset:1024  lds
v_mfma_f32_16x16x32_bf16 v[76:79], a[76:79], a[16:19], v[76:79]
ds_read_b64_tr_b16 v[42:43], v64 offset:0
v_mfma_f32_16x16x32_bf16 v[76:79], a[80:83], a[20:23], v[76:79]
ds_read_b64_tr_b16 v[46:47], v64 offset:32
v_cvt_pk_bf16_f32 v40, v72, v73
v_mfma_f32_16x16x32_bf16 v[80:83], a[72:75], a[24:27], 0
buffer_load_dwordx4 v8, s[4:7], s53 offen offset:2048  lds
v_mfma_f32_16x16x32_bf16 v[80:83], a[76:79], a[28:31], v[80:83]
v_cvt_pk_bf16_f32 v41, v74, v75
s_nop 0
v_mfma_f32_16x16x32_bf16 v[80:83], a[80:83], a[32:35], v[80:83]
s_waitcnt lgkmcnt(1)
ds_read_b64_tr_b16 v[50:51], v64 offset:64
v_mov_b32_dpp v42, v164 quad_perm:[0,1,2,3] row_mask:0x8 bank_mask:0xf
v_mfma_f32_16x16x32_bf16 v[84:87], a[72:75], a[36:39], 0
v_mov_b32_dpp v43, v165 quad_perm:[0,1,2,3] row_mask:0x8 bank_mask:0xf
v_cvt_pk_bf16_f32 v44, v76, v77
v_mfma_f32_16x16x32_bf16 v[84:87], a[76:79], a[40:43], v[84:87]
ds_read_b64_tr_b16 v[54:55], v64 offset:96
v_cvt_pk_bf16_f32 v45, v78, v79
v_mfma_f32_16x16x32_bf16 v[84:87], a[80:83], a[44:47], v[84:87]
v_cvt_pk_bf16_f32 v48, v80, v81
v_cvt_pk_bf16_f32 v49, v82, v83
v_mfma_f32_16x16x32_bf16 v[88:91], v[40:43], v[24:27], 0
ds_read_b64_tr_b16 v[58:59], v64 offset:128
s_nop 0
v_mfma_f32_16x16x32_bf16 v[92:95], v[40:43], v[28:31], 0
s_waitcnt lgkmcnt(3)
v_mov_b32_dpp v46, v166 quad_perm:[0,1,2,3] row_mask:0x8 bank_mask:0xf
v_mov_b32_dpp v47, v167 quad_perm:[0,1,2,3] row_mask:0x8 bank_mask:0xf
v_mfma_f32_16x16x32_bf16 v[72:75], a[72:75], a[48:51], 0
ds_read_b64_tr_b16 v[62:63], v64 offset:160
v_cvt_pk_bf16_f32 v52, v84, v85
v_mfma_f32_16x16x32_bf16 v[72:75], a[76:79], a[52:55], v[72:75]
v_cvt_pk_bf16_f32 v53, v86, v87
v_cvt_pk_bf16_f32 v176, v88, v89
v_mfma_f32_16x16x32_bf16 v[72:75], a[80:83], a[56:59], v[72:75]
v_cvt_pk_bf16_f32 v177, v90, v91
v_cvt_pk_bf16_f32 v196, v92, v93
v_mfma_f32_16x16x32_bf16 v[96:99], v[44:47], v[24:27], 0
v_cvt_pk_bf16_f32 v197, v94, v95
s_nop 0
v_mfma_f32_16x16x32_bf16 v[100:103], v[44:47], v[28:31], 0
s_waitcnt lgkmcnt(3)
v_mov_b32_dpp v50, v168 quad_perm:[0,1,2,3] row_mask:0x8 bank_mask:0xf
v_mov_b32_dpp v51, v169 quad_perm:[0,1,2,3] row_mask:0x8 bank_mask:0xf
v_mfma_f32_16x16x32_bf16 v[76:79], a[72:75], a[60:63], 0
v_cvt_pk_bf16_f32 v56, v72, v73
v_cvt_pk_bf16_f32 v57, v74, v75
v_mfma_f32_16x16x32_bf16 v[76:79], a[76:79], a[64:67], v[76:79]
s_waitcnt lgkmcnt(2)
v_mov_b32_dpp v54, v170 quad_perm:[0,1,2,3] row_mask:0x8 bank_mask:0xf
v_mov_b32_dpp v55, v171 quad_perm:[0,1,2,3] row_mask:0x8 bank_mask:0xf
v_mfma_f32_16x16x32_bf16 v[76:79], a[80:83], a[68:71], v[76:79]
v_cvt_pk_bf16_f32 v178, v96, v97
v_cvt_pk_bf16_f32 v179, v98, v99
v_mfma_f32_16x16x32_bf16 v[104:107], v[48:51], v[24:27], 0
s_waitcnt lgkmcnt(1)
v_mov_b32_dpp v58, v172 quad_perm:[0,1,2,3] row_mask:0x8 bank_mask:0xf
v_mov_b32_dpp v59, v173 quad_perm:[0,1,2,3] row_mask:0x8 bank_mask:0xf
v_mfma_f32_16x16x32_bf16 v[108:111], v[48:51], v[28:31], 0
s_waitcnt vmcnt(8)
ds_read_b128 a[84:87], v14 offset:3072
v_cvt_pk_bf16_f32 v60, v76, v77
v_mfma_f32_16x16x32_bf16 v[112:115], v[52:55], v[24:27], 0
ds_read_b128 a[88:91], v14 offset:3136
v_cvt_pk_bf16_f32 v61, v78, v79
v_mfma_f32_16x16x32_bf16 v[116:119], v[52:55], v[28:31], 0
s_waitcnt lgkmcnt(2)
ds_read_b128 a[92:95], v14 offset:3200
v_mov_b32_dpp v62, v174 quad_perm:[0,1,2,3] row_mask:0x8 bank_mask:0xf
v_mfma_f32_16x16x32_bf16 v[120:123], v[56:59], v[24:27], 0
s_add_u32 m0, s58, 12288
v_mov_b32_dpp v63, v175 quad_perm:[0,1,2,3] row_mask:0x8 bank_mask:0xf
v_cvt_pk_bf16_f32 v198, v100, v101
v_mfma_f32_16x16x32_bf16 v[124:127], v[56:59], v[28:31], 0
buffer_load_dwordx4 v6, s[4:7], s54 offen offset:0  lds
v_mfma_f32_16x16x32_bf16 v[88:91], v[60:63], v[24:27], 0
buffer_load_dwordx4 v7, s[4:7], s54 offen offset:1024  lds
v_mfma_f32_16x16x32_bf16 v[92:95], v[60:63], v[28:31], 0
s_waitcnt lgkmcnt(2)
v_cvt_pk_bf16_f32 v199, v102, v103
v_cvt_pk_bf16_f32 v136, v104, v105
v_mfma_f32_16x16x32_bf16 v[80:83], a[84:87], a[0:3], 0
s_waitcnt lgkmcnt(1)
buffer_load_dwordx4 v8, s[4:7], s54 offen offset:2048  lds
v_mfma_f32_16x16x32_bf16 v[80:83], a[88:91], a[4:7], v[80:83]
s_waitcnt lgkmcnt(0)
ds_read_b64_tr_b16 v[42:43], v65 offset:0
v_cvt_pk_bf16_f32 v137, v106, v107
v_mfma_f32_16x16x32_bf16 v[80:83], a[92:95], a[8:11], v[80:83]
v_cvt_pk_bf16_f32 v200, v108, v109
v_cvt_pk_bf16_f32 v201, v110, v111
v_mfma_f32_16x16x32_bf16 v[84:87], a[84:87], a[12:15], 0
v_cvt_pk_bf16_f32 v138, v112, v113
v_cvt_pk_bf16_f32 v139, v114, v115
v_mfma_f32_16x16x32_bf16 v[84:87], a[88:91], a[16:19], v[84:87]
v_cvt_pk_bf16_f32 v202, v116, v117
v_cvt_pk_bf16_f32 v203, v118, v119
v_mfma_f32_16x16x32_bf16 v[84:87], a[92:95], a[20:23], v[84:87]
v_cvt_pk_bf16_f32 v40, v80, v81
v_cvt_pk_bf16_f32 v41, v82, v83
v_mfma_f32_16x16x32_bf16 v[72:75], a[84:87], a[24:27], 0
ds_read_b64_tr_b16 v[46:47], v65 offset:32
v_cvt_pk_bf16_f32 v140, v120, v121
v_mfma_f32_16x16x32_bf16 v[72:75], a[88:91], a[28:31], v[72:75]
v_cvt_pk_bf16_f32 v141, v122, v123
v_cvt_pk_bf16_f32 v204, v124, v125
v_mfma_f32_16x16x32_bf16 v[72:75], a[92:95], a[32:35], v[72:75]
v_cvt_pk_bf16_f32 v44, v84, v85
v_cvt_pk_bf16_f32 v45, v86, v87
v_mfma_f32_16x16x32_bf16 v[76:79], a[84:87], a[36:39], 0
v_cvt_pk_bf16_f32 v205, v126, v127
v_cvt_pk_bf16_f32 v142, v88, v89
v_mfma_f32_16x16x32_bf16 v[76:79], a[88:91], a[40:43], v[76:79]
v_cvt_pk_bf16_f32 v143, v90, v91
v_cvt_pk_bf16_f32 v206, v92, v93
v_mfma_f32_16x16x32_bf16 v[76:79], a[92:95], a[44:47], v[76:79]
s_waitcnt lgkmcnt(1)
ds_read_b64_tr_b16 v[50:51], v65 offset:64
v_cvt_pk_bf16_f32 v48, v72, v73
v_mfma_f32_16x16x32_bf16 v[96:99], v[40:43], v[24:27], 0
v_cvt_pk_bf16_f32 v49, v74, v75
v_cvt_pk_bf16_f32 v207, v94, v95
v_mfma_f32_16x16x32_bf16 v[100:103], v[40:43], v[28:31], 0
ds_read_b64_tr_b16 v[54:55], v65 offset:96
v_cvt_pk_bf16_f32 v52, v76, v77
v_mfma_f32_16x16x32_bf16 v[80:83], a[84:87], a[48:51], 0
v_cvt_pk_bf16_f32 v53, v78, v79
v_mfma_f32_16x16x32_bf16 v[80:83], a[88:91], a[52:55], v[80:83]
ds_read_b64_tr_b16 v[58:59], v65 offset:128
v_cvt_pk_bf16_f32 v180, v96, v97
v_mfma_f32_16x16x32_bf16 v[80:83], a[92:95], a[56:59], v[80:83]
s_waitcnt lgkmcnt(3)
v_cvt_pk_bf16_f32 v181, v98, v99
v_cvt_pk_bf16_f32 v208, v100, v101
v_mfma_f32_16x16x32_bf16 v[104:107], v[44:47], v[24:27], 0
ds_read_b64_tr_b16 v[62:63], v65 offset:160
v_cvt_pk_bf16_f32 v209, v102, v103
v_mfma_f32_16x16x32_bf16 v[108:111], v[44:47], v[28:31], 0
v_mfma_f32_16x16x32_bf16 v[84:87], a[84:87], a[60:63], 0
v_cvt_pk_bf16_f32 v56, v80, v81
v_cvt_pk_bf16_f32 v57, v82, v83
v_mfma_f32_16x16x32_bf16 v[84:87], a[88:91], a[64:67], v[84:87]
v_mfma_f32_16x16x32_bf16 v[84:87], a[92:95], a[68:71], v[84:87]
s_waitcnt lgkmcnt(3)
v_cvt_pk_bf16_f32 v182, v104, v105
v_cvt_pk_bf16_f32 v183, v106, v107
v_mfma_f32_16x16x32_bf16 v[112:115], v[48:51], v[24:27], 0
v_cvt_pk_bf16_f32 v210, v108, v109
v_cvt_pk_bf16_f32 v211, v110, v111
v_mfma_f32_16x16x32_bf16 v[116:119], v[48:51], v[28:31], 0
s_waitcnt lgkmcnt(2)
s_waitcnt vmcnt(8)
ds_read_b128 a[72:75], v14 offset:6144
v_mfma_f32_16x16x32_bf16 v[120:123], v[52:55], v[24:27], 0
ds_read_b128 a[76:79], v14 offset:6208
v_cvt_pk_bf16_f32 v60, v84, v85
v_mfma_f32_16x16x32_bf16 v[124:127], v[52:55], v[28:31], 0
s_waitcnt lgkmcnt(3)
ds_read_b128 a[80:83], v14 offset:6272
v_cvt_pk_bf16_f32 v61, v86, v87
v_mfma_f32_16x16x32_bf16 v[88:91], v[56:59], v[24:27], 0
s_add_u32 m0, s58, 19200
v_cvt_pk_bf16_f32 v144, v112, v113
v_cvt_pk_bf16_f32 v145, v114, v115
v_mfma_f32_16x16x32_bf16 v[92:95], v[56:59], v[28:31], 0
s_waitcnt lgkmcnt(3)
buffer_load_dwordx4 v12, s[8:11], s57 offen offset:0  lds
v_mfma_f32_16x16x32_bf16 v[96:99], v[60:63], v[24:27], 0
s_bfm_b64 exec, 56, 0
buffer_load_dwordx4 v13, s[8:11], s57 offen offset:1024  lds
s_mov_b64 exec, -1
v_mfma_f32_16x16x32_bf16 v[100:103], v[60:63], v[28:31], 0
s_waitcnt lgkmcnt(2)
v_cvt_pk_bf16_f32 v212, v116, v117
v_cvt_pk_bf16_f32 v213, v118, v119
v_mfma_f32_16x16x32_bf16 v[72:75], a[72:75], a[0:3], 0
s_waitcnt lgkmcnt(1)
v_cvt_pk_bf16_f32 v146, v120, v121
v_cvt_pk_bf16_f32 v147, v122, v123
v_mfma_f32_16x16x32_bf16 v[72:75], a[76:79], a[4:7], v[72:75]
s_waitcnt lgkmcnt(0)
v_cvt_pk_bf16_f32 v214, v124, v125
v_cvt_pk_bf16_f32 v215, v126, v127
v_mfma_f32_16x16x32_bf16 v[72:75], a[80:83], a[8:11], v[72:75]
v_cvt_pk_bf16_f32 v148, v88, v89
v_cvt_pk_bf16_f32 v149, v90, v91
v_mfma_f32_16x16x32_bf16 v[76:79], a[72:75], a[12:15], 0
v_cvt_pk_bf16_f32 v216, v92, v93
v_cvt_pk_bf16_f32 v217, v94, v95
v_mfma_f32_16x16x32_bf16 v[76:79], a[76:79], a[16:19], v[76:79]
v_cvt_pk_bf16_f32 v150, v96, v97
v_cvt_pk_bf16_f32 v151, v98, v99
v_mfma_f32_16x16x32_bf16 v[76:79], a[80:83], a[20:23], v[76:79]
v_cvt_pk_bf16_f32 v40, v72, v73
v_cvt_pk_bf16_f32 v41, v74, v75
v_mfma_f32_16x16x32_bf16 v[80:83], a[72:75], a[24:27], 0
s_waitcnt vmcnt(8)
v_cvt_pk_bf16_f32 v218, v100, v101
v_cvt_pk_bf16_f32 v219, v102, v103
v_mfma_f32_16x16x32_bf16 v[80:83], a[76:79], a[28:31], v[80:83]
ds_read_b64_tr_b16 v[42:43], v66 offset:0
v_cvt_pk_bf16_f32 v44, v76, v77
v_mfma_f32_16x16x32_bf16 v[80:83], a[80:83], a[32:35], v[80:83]
ds_read_b64_tr_b16 v[46:47], v66 offset:32
v_cvt_pk_bf16_f32 v45, v78, v79
v_mfma_f32_16x16x32_bf16 v[84:87], a[72:75], a[36:39], 0
s_nop 2
v_mfma_f32_16x16x32_bf16 v[84:87], a[76:79], a[40:43], v[84:87]
global_load_dwordx2 v[132:133], v69, s[46:47] offset:0 sc1
v_cvt_pk_bf16_f32 v48, v80, v81
v_mfma_f32_16x16x32_bf16 v[84:87], a[80:83], a[44:47], v[84:87]
s_waitcnt lgkmcnt(1)
ds_read_b64_tr_b16 v[50:51], v66 offset:64
v_cvt_pk_bf16_f32 v49, v82, v83
v_mfma_f32_16x16x32_bf16 v[104:107], v[40:43], v[24:27], 0
s_nop 2
v_mfma_f32_16x16x32_bf16 v[108:111], v[40:43], v[28:31], 0
ds_read_b64_tr_b16 v[54:55], v66 offset:96
v_cvt_pk_bf16_f32 v52, v84, v85
v_mfma_f32_16x16x32_bf16 v[72:75], a[72:75], a[48:51], 0
v_cvt_pk_bf16_f32 v53, v86, v87
v_cvt_pk_bf16_f32 v184, v104, v105
v_mfma_f32_16x16x32_bf16 v[72:75], a[76:79], a[52:55], v[72:75]
ds_read_b64_tr_b16 v[58:59], v66 offset:128
v_cvt_pk_bf16_f32 v185, v106, v107
v_mfma_f32_16x16x32_bf16 v[72:75], a[80:83], a[56:59], v[72:75]
s_waitcnt lgkmcnt(3)
v_cvt_pk_bf16_f32 v220, v108, v109
v_cvt_pk_bf16_f32 v221, v110, v111
v_mfma_f32_16x16x32_bf16 v[112:115], v[44:47], v[24:27], 0
ds_read_b64_tr_b16 v[62:63], v66 offset:160
s_nop 0
v_mfma_f32_16x16x32_bf16 v[116:119], v[44:47], v[28:31], 0
v_mfma_f32_16x16x32_bf16 v[76:79], a[72:75], a[60:63], 0
v_cvt_pk_bf16_f32 v56, v72, v73
v_cvt_pk_bf16_f32 v57, v74, v75
v_mfma_f32_16x16x32_bf16 v[76:79], a[76:79], a[64:67], v[76:79]
v_mfma_f32_16x16x32_bf16 v[76:79], a[80:83], a[68:71], v[76:79]
s_waitcnt lgkmcnt(3)
v_cvt_pk_bf16_f32 v186, v112, v113
v_cvt_pk_bf16_f32 v187, v114, v115
v_mfma_f32_16x16x32_bf16 v[120:123], v[48:51], v[24:27], 0
global_load_dwordx2 v[134:135], v70, s[48:49] offset:0 sc1
v_cvt_pk_bf16_f32 v222, v116, v117
v_mfma_f32_16x16x32_bf16 v[124:127], v[48:51], v[28:31], 0
s_waitcnt lgkmcnt(2)
s_waitcnt vmcnt(7)
ds_read_b128 a[84:87], v14 offset:9216
v_mfma_f32_16x16x32_bf16 v[88:91], v[52:55], v[24:27], 0
ds_read_b128 a[88:91], v14 offset:9280
v_cvt_pk_bf16_f32 v60, v76, v77
v_mfma_f32_16x16x32_bf16 v[92:95], v[52:55], v[28:31], 0
s_waitcnt lgkmcnt(3)
ds_read_b128 a[92:95], v14 offset:9344
v_cvt_pk_bf16_f32 v61, v78, v79
v_mfma_f32_16x16x32_bf16 v[96:99], v[56:59], v[24:27], 0
v_cvt_pk_bf16_f32 v223, v118, v119
v_cvt_pk_bf16_f32 v152, v120, v121
v_mfma_f32_16x16x32_bf16 v[100:103], v[56:59], v[28:31], 0
s_waitcnt lgkmcnt(3)
v_cvt_pk_bf16_f32 v153, v122, v123
v_cvt_pk_bf16_f32 v224, v124, v125
v_mfma_f32_16x16x32_bf16 v[104:107], v[60:63], v[24:27], 0
v_cvt_pk_bf16_f32 v225, v126, v127
v_cvt_pk_bf16_f32 v154, v88, v89
v_mfma_f32_16x16x32_bf16 v[108:111], v[60:63], v[28:31], 0
s_waitcnt lgkmcnt(2)
v_cvt_pk_bf16_f32 v155, v90, v91
v_cvt_pk_bf16_f32 v226, v92, v93
v_mfma_f32_16x16x32_bf16 v[80:83], a[84:87], a[0:3], 0
s_waitcnt lgkmcnt(1)
v_cvt_pk_bf16_f32 v227, v94, v95
v_cvt_pk_bf16_f32 v156, v96, v97
v_mfma_f32_16x16x32_bf16 v[80:83], a[88:91], a[4:7], v[80:83]
s_waitcnt lgkmcnt(0)
ds_read_b64_tr_b16 v[42:43], v67 offset:0
v_cvt_pk_bf16_f32 v157, v98, v99
v_mfma_f32_16x16x32_bf16 v[80:83], a[92:95], a[8:11], v[80:83]
v_cvt_pk_bf16_f32 v228, v100, v101
v_cvt_pk_bf16_f32 v229, v102, v103
v_mfma_f32_16x16x32_bf16 v[84:87], a[84:87], a[12:15], 0
v_cvt_pk_bf16_f32 v158, v104, v105
v_cvt_pk_bf16_f32 v159, v106, v107
v_mfma_f32_16x16x32_bf16 v[84:87], a[88:91], a[16:19], v[84:87]
v_cvt_pk_bf16_f32 v230, v108, v109
v_cvt_pk_bf16_f32 v231, v110, v111
v_mfma_f32_16x16x32_bf16 v[84:87], a[92:95], a[20:23], v[84:87]
v_cvt_pk_bf16_f32 v40, v80, v81
v_cvt_pk_bf16_f32 v41, v82, v83
v_mfma_f32_16x16x32_bf16 v[72:75], a[84:87], a[24:27], 0
ds_read_b64_tr_b16 v[46:47], v67 offset:32
s_nop 0
v_mfma_f32_16x16x32_bf16 v[72:75], a[88:91], a[28:31], v[72:75]
s_nop 0
v_mfma_f32_16x16x32_bf16 v[72:75], a[92:95], a[32:35], v[72:75]
v_cvt_pk_bf16_f32 v44, v84, v85
v_cvt_pk_bf16_f32 v45, v86, v87
v_mfma_f32_16x16x32_bf16 v[76:79], a[84:87], a[36:39], 0
s_nop 2
v_mfma_f32_16x16x32_bf16 v[76:79], a[88:91], a[40:43], v[76:79]
v_mfma_f32_16x16x32_bf16 v[76:79], a[92:95], a[44:47], v[76:79]
s_waitcnt lgkmcnt(1)
ds_read_b64_tr_b16 v[50:51], v67 offset:64
v_cvt_pk_bf16_f32 v48, v72, v73
v_mfma_f32_16x16x32_bf16 v[112:115], v[40:43], v[24:27], 0
v_cvt_pk_bf16_f32 v49, v74, v75
s_nop 0
v_mfma_f32_16x16x32_bf16 v[116:119], v[40:43], v[28:31], 0
s_waitcnt vmcnt(0)
ds_read_b64_tr_b16 v[54:55], v67 offset:96
v_cmp_ne_u64 s[82:83], v[132:133], v[134:135]
v_mfma_f32_16x16x32_bf16 v[80:83], a[84:87], a[48:51], 0
v_cmp_eq_u32 vcc, 0, v132
v_cvt_pk_bf16_f32 v52, v76, v77
v_mfma_f32_16x16x32_bf16 v[80:83], a[88:91], a[52:55], v[80:83]
s_or_b64 s[82:83], s[82:83], vcc
s_cbranch_scc1 L_late
L_go:
v_mfma_f32_16x16x32_bf16 v[80:83], a[92:95], a[56:59], v[80:83]
s_waitcnt lgkmcnt(2)
ds_read_b64_tr_b16 v[58:59], v67 offset:128
global_load_dwordx4 a[112:115], v1, s[48:49] offset:-4096 sc1
v_mfma_f32_16x16x32_bf16 v[120:123], v[44:47], v[24:27], 0
ds_read_b64_tr_b16 v[62:63], v67 offset:160
v_cvt_pk_bf16_f32 v53, v78, v79
v_mfma_f32_16x16x32_bf16 v[124:127], v[44:47], v[28:31], 0
v_cvt_pk_bf16_f32 v188, v112, v113
v_cvt_pk_bf16_f32 v56, v80, v81
v_mfma_f32_16x16x32_bf16 v[84:87], a[84:87], a[60:63], 0
global_load_dwordx4 a[116:119], v1, s[48:49] offset:-3072 sc1
v_cvt_pk_bf16_f32 v57, v82, v83
v_mfma_f32_16x16x32_bf16 v[84:87], a[88:91], a[64:67], v[84:87]
v_cvt_pk_bf16_f32 v189, v114, v115
v_cvt_pk_bf16_f32 v232, v116, v117
v_mfma_f32_16x16x32_bf16 v[84:87], a[92:95], a[68:71], v[84:87]
s_waitcnt lgkmcnt(3)
v_cvt_pk_bf16_f32 v233, v118, v119
v_cvt_pk_bf16_f32 v190, v120, v121
v_mfma_f32_16x16x32_bf16 v[88:91], v[48:51], v[24:27], 0
global_load_dwordx4 a[120:123], v1, s[48:49] offset:-2048 sc1
v_cvt_pk_bf16_f32 v191, v122, v123
v_mfma_f32_16x16x32_bf16 v[92:95], v[48:51], v[28:31], 0
s_waitcnt lgkmcnt(2)
ds_read_b128 a[72:75], v14 offset:12288
v_cvt_pk_bf16_f32 v60, v84, v85
v_mfma_f32_16x16x32_bf16 v[96:99], v[52:55], v[24:27], 0
ds_read_b128 a[76:79], v14 offset:12352
v_cvt_pk_bf16_f32 v61, v86, v87
v_mfma_f32_16x16x32_bf16 v[100:103], v[52:55], v[28:31], 0
s_waitcnt lgkmcnt(3)
ds_read_b128 a[80:83], v14 offset:12416
v_cvt_pk_bf16_f32 v234, v124, v125
v_mfma_f32_16x16x32_bf16 v[104:107], v[56:59], v[24:27], 0
global_load_dwordx4 a[124:127], v1, s[48:49] offset:-1024 sc1
v_cvt_pk_bf16_f32 v235, v126, v127
v_mfma_f32_16x16x32_bf16 v[108:111], v[56:59], v[28:31], 0
s_waitcnt lgkmcnt(3)
v_cvt_pk_bf16_f32 v160, v88, v89
v_cvt_pk_bf16_f32 v161, v90, v91
v_mfma_f32_16x16x32_bf16 v[112:115], v[60:63], v[24:27], 0
v_cvt_pk_bf16_f32 v236, v92, v93
v_cvt_pk_bf16_f32 v237, v94, v95
v_mfma_f32_16x16x32_bf16 v[116:119], v[60:63], v[28:31], 0
s_waitcnt lgkmcnt(2)
global_load_dwordx4 a[128:131], v1, s[48:49] offset:0 sc1
v_cvt_pk_bf16_f32 v162, v96, v97
v_mfma_f32_16x16x32_bf16 v[72:75], a[72:75], a[0:3], 0
s_waitcnt lgkmcnt(1)
ds_write_b128 v0, v[176:179] offset:0
v_mfma_f32_16x16x32_bf16 v[72:75], a[76:79], a[4:7], v[72:75]
s_waitcnt lgkmcnt(1)
v_cvt_pk_bf16_f32 v163, v98, v99
v_cvt_pk_bf16_f32 v238, v100, v101
v_mfma_f32_16x16x32_bf16 v[72:75], a[80:83], a[8:11], v[72:75]
v_cvt_pk_bf16_f32 v239, v102, v103
v_cvt_pk_bf16_f32 v164, v104, v105
v_mfma_f32_16x16x32_bf16 v[76:79], a[72:75], a[12:15], 0
global_load_dwordx4 a[132:135], v1, s[48:49] offset:1024 sc1
v_cvt_pk_bf16_f32 v165, v106, v107
v_mfma_f32_16x16x32_bf16 v[76:79], a[76:79], a[16:19], v[76:79]
ds_read_b64_tr_b16 v[42:43], v68 offset:0
v_cvt_pk_bf16_f32 v240, v108, v109
v_mfma_f32_16x16x32_bf16 v[76:79], a[80:83], a[20:23], v[76:79]
ds_write_b128 v0, v[180:183] offset:16
v_mfma_f32_16x16x32_bf16 v[80:83], a[72:75], a[24:27], 0
global_load_dwordx4 a[136:139], v1, s[48:49] offset:2048 sc1
v_cvt_pk_bf16_f32 v40, v72, v73
v_mfma_f32_16x16x32_bf16 v[80:83], a[76:79], a[28:31], v[80:83]
v_cvt_pk_bf16_f32 v41, v74, v75
v_cvt_pk_bf16_f32 v241, v110, v111
v_mfma_f32_16x16x32_bf16 v[80:83], a[80:83], a[32:35], v[80:83]
s_waitcnt lgkmcnt(1)
ds_read_b64_tr_b16 v[46:47], v68 offset:32
v_cvt_pk_bf16_f32 v44, v76, v77
v_mfma_f32_16x16x32_bf16 v[120:123], v[40:43], v[24:27], 0
ds_write_b128 v192, v[184:187] offset:0
v_mfma_f32_16x16x32_bf16 v[124:127], v[40:43], v[28:31], 0
global_load_dwordx4 a[140:143], v1, s[48:49] offset:3072 sc1
v_add_u32 v1, 0x2000, v1
v_mfma_f32_16x16x32_bf16 v[84:87], a[72:75], a[36:39], 0
v_cvt_pk_bf16_f32 v45, v78, v79
v_cvt_pk_bf16_f32 v48, v80, v81
v_mfma_f32_16x16x32_bf16 v[84:87], a[76:79], a[40:43], v[84:87]
ds_write_b128 v192, v[188:191] offset:16
v_mfma_f32_16x16x32_bf16 v[84:87], a[80:83], a[44:47], v[84:87]
s_waitcnt lgkmcnt(2)
global_load_dwordx4 a[144:147], v1, s[48:49] offset:-4096 sc1
v_cvt_pk_bf16_f32 v128, v120, v121
v_mfma_f32_16x16x32_bf16 v[88:91], v[44:47], v[24:27], 0
v_cvt_pk_bf16_f32 v129, v122, v123
v_cvt_pk_bf16_f32 v49, v82, v83
v_mfma_f32_16x16x32_bf16 v[92:95], v[44:47], v[28:31], 0
ds_read_b64_tr_b16 v[50:51], v68 offset:64
v_cvt_pk_bf16_f32 v52, v84, v85
v_mfma_f32_16x16x32_bf16 v[72:75], a[72:75], a[48:51], 0
ds_read_b64_tr_b16 v[54:55], v68 offset:96
global_load_dwordx4 a[148:151], v1, s[48:49] offset:-3072 sc1
v_mfma_f32_16x16x32_bf16 v[72:75], a[76:79], a[52:55], v[72:75]
ds_read_b64_tr_b16 v[58:59], v68 offset:128
v_cvt_pk_bf16_f32 v130, v88, v89
v_mfma_f32_16x16x32_bf16 v[72:75], a[80:83], a[56:59], v[72:75]
ds_read_b64_tr_b16 v[62:63], v68 offset:160
v_cvt_pk_bf16_f32 v131, v90, v91
v_mfma_f32_16x16x32_bf16 v[76:79], a[72:75], a[60:63], 0
ds_write_b128 v193, v[128:131] offset:0
v_mfma_f32_16x16x32_bf16 v[76:79], a[76:79], a[64:67], v[76:79]
global_load_dwordx4 a[152:155], v1, s[48:49] offset:-2048 sc1
v_cvt_pk_bf16_f32 v53, v86, v87
v_mfma_f32_16x16x32_bf16 v[76:79], a[80:83], a[68:71], v[76:79]
s_waitcnt lgkmcnt(4)
v_cvt_pk_bf16_f32 v56, v72, v73
v_cvt_pk_bf16_f32 v57, v74, v75
v_mfma_f32_16x16x32_bf16 v[96:99], v[48:51], v[24:27], 0
v_cvt_pk_bf16_f32 v166, v112, v113
v_cvt_pk_bf16_f32 v167, v114, v115
v_mfma_f32_16x16x32_bf16 v[100:103], v[48:51], v[28:31], 0
s_waitcnt lgkmcnt(3)
global_load_dwordx4 a[156:159], v1, s[48:49] offset:-1024 sc1
v_cvt_pk_bf16_f32 v60, v76, v77
v_mfma_f32_16x16x32_bf16 v[104:107], v[52:55], v[24:27], 0
s_waitcnt lgkmcnt(0)
s_barrier
ds_read_b128 a[0:3], v2 offset:31232
v_mfma_f32_16x16x32_bf16 v[108:111], v[52:55], v[28:31], 0
ds_read_b128 a[4:7], v2 offset:33168
v_cvt_pk_bf16_f32 v61, v78, v79
v_mfma_f32_16x16x32_bf16 v[112:115], v[56:59], v[24:27], 0
global_load_dwordx4 a[160:163], v1, s[48:49] offset:0 sc1
ds_read_b128 a[8:11], v2 offset:35104
v_cvt_pk_bf16_f32 v242, v116, v117
v_cvt_pk_bf16_f32 v243, v118, v119
v_mfma_f32_16x16x32_bf16 v[116:119], v[56:59], v[28:31], 0
ds_read_b128 a[12:15], v2 offset:37040
v_cvt_pk_bf16_f32 v244, v124, v125
v_mfma_f32_16x16x32_bf16 v[120:123], v[60:63], v[24:27], 0
v_cvt_pk_bf16_f32 v245, v126, v127
v_cvt_pk_bf16_f32 v246, v92, v93
v_mfma_f32_16x16x32_bf16 v[124:127], v[60:63], v[28:31], 0
s_waitcnt vmcnt(12) lgkmcnt(3)
v_cvt_pk_bf16_f32 v247, v94, v95
v_cvt_pk_bf16_f32 v168, v96, v97
v_mfma_f32_16x16x32_bf16 v[4:7], a[112:115], a[0:3], 0
s_waitcnt vmcnt(11)
global_load_dwordx4 a[164:167], v1, s[48:49] offset:1024 sc1
ds_read_b128 a[16:19], v2 offset:31248
v_mfma_f32_16x16x32_bf16 v[8:11], a[116:119], a[0:3], 0
s_waitcnt vmcnt(11)
ds_write_b128 v0, v[136:139] offset:640
v_mfma_f32_16x16x32_bf16 v[12:15], a[120:123], a[0:3], 0
s_waitcnt lgkmcnt(4)
v_cvt_pk_bf16_f32 v169, v98, v99
v_cvt_pk_bf16_f32 v248, v100, v101
v_mfma_f32_16x16x32_bf16 v[24:27], a[120:123], a[4:7], 0
global_load_dwordx4 a[168:171], v1, s[48:49] offset:2048 sc1
v_cvt_pk_bf16_f32 v249, v102, v103
v_mfma_f32_16x16x32_bf16 v[20:23], a[116:119], a[4:7], 0
ds_read_b128 a[20:23], v2 offset:33184
v_cvt_pk_bf16_f32 v170, v104, v105
v_mfma_f32_16x16x32_bf16 v[16:19], a[112:115], a[4:7], 0
s_waitcnt lgkmcnt(4)
ds_write_b128 v0, v[140:143] offset:1280
v_mfma_f32_16x16x32_bf16 v[28:31], a[112:115], a[8:11], 0
global_load_dwordx4 a[172:175], v1, s[48:49] offset:3072 sc1
v_cvt_pk_bf16_f32 v171, v106, v107
v_mfma_f32_16x16x32_bf16 v[32:35], a[116:119], a[8:11], 0
v_cvt_pk_bf16_f32 v250, v108, v109
v_cvt_pk_bf16_f32 v251, v110, v111
v_mfma_f32_16x16x32_bf16 v[36:39], a[120:123], a[8:11], 0
s_waitcnt lgkmcnt(4)
ds_read_b128 a[24:27], v2 offset:35120
v_cvt_pk_bf16_f32 v172, v112, v113
v_mfma_f32_16x16x32_bf16 v[48:51], a[120:123], a[12:15], 0
ds_write_b128 v0, v[144:147] offset:656
v_cvt_pk_bf16_f32 v173, v114, v115
v_mfma_f32_16x16x32_bf16 v[44:47], a[116:119], a[12:15], 0
v_cvt_pk_bf16_f32 v252, v116, v117
v_cvt_pk_bf16_f32 v253, v118, v119
v_mfma_f32_16x16x32_bf16 v[40:43], a[112:115], a[12:15], 0
s_waitcnt vmcnt(12) lgkmcnt(5)
v_cvt_pk_bf16_f32 v174, v120, v121
v_cvt_pk_bf16_f32 v175, v122, v123
v_mfma_f32_16x16x32_bf16 v[4:7], a[124:127], a[16:19], v[4:7]
s_waitcnt vmcnt(11)
ds_read_b128 a[28:31], v2 offset:37056
v_cvt_pk_bf16_f32 v254, v124, v125
v_cvt_pk_bf16_f32 v255, v126, v127
v_mfma_f32_16x16x32_bf16 v[8:11], a[128:131], a[16:19], v[8:11]
s_waitcnt vmcnt(10)
ds_write_b128 v0, v[148:151] offset:1296
v_mfma_f32_16x16x32_bf16 v[12:15], a[132:135], a[16:19], v[12:15]
s_waitcnt lgkmcnt(5)
v_add_u32 v1, 0x2000, v1
v_mfma_f32_16x16x32_bf16 v[24:27], a[132:135], a[20:23], v[24:27]
global_load_dwordx4 a[176:179], v1, s[48:49] offset:-4096 sc1
v_mfma_f32_16x16x32_bf16 v[20:23], a[128:131], a[20:23], v[20:23]
global_load_dwordx4 a[180:183], v1, s[48:49] offset:-3072 sc1
ds_read_b128 a[0:3], v2 offset:31264
v_mfma_f32_16x16x32_bf16 v[16:19], a[124:127], a[20:23], v[16:19]
s_waitcnt lgkmcnt(4)
global_load_dwordx4 a[184:187], v1, s[48:49] offset:-2048 sc1
ds_read_b128 a[4:7], v2 offset:33200
v_mfma_f32_16x16x32_bf16 v[28:31], a[124:127], a[24:27], v[28:31]
ds_write_b128 v192, v[152:155] offset:640
v_mfma_f32_16x16x32_bf16 v[32:35], a[128:131], a[24:27], v[32:35]
global_load_dwordx4 a[188:191], v1, s[48:49] offset:-1024 sc1
v_mfma_f32_16x16x32_bf16 v[36:39], a[132:135], a[24:27], v[36:39]
s_waitcnt lgkmcnt(4)
v_mfma_f32_16x16x32_bf16 v[48:51], a[132:135], a[28:31], v[48:51]
ds_read_b128 a[8:11], v2 offset:35136
v_mfma_f32_16x16x32_bf16 v[44:47], a[128:131], a[28:31], v[44:47]
ds_write_b128 v192, v[156:159] offset:1280
v_mfma_f32_16x16x32_bf16 v[40:43], a[124:127], a[28:31], v[40:43]
s_waitcnt vmcnt(13) lgkmcnt(4)
global_load_dwordx4 a[192:195], v1, s[48:49] offset:0 sc1
v_mfma_f32_16x16x32_bf16 v[4:7], a[136:139], a[0:3], v[4:7]
s_waitcnt vmcnt(13)
v_mfma_f32_16x16x32_bf16 v[8:11], a[140:143], a[0:3], v[8:11]
s_waitcnt vmcnt(12)
ds_read_b128 a[12:15], v2 offset:37072
v_mfma_f32_16x16x32_bf16 v[12:15], a[144:147], a[0:3], v[12:15]
s_waitcnt lgkmcnt(4)
global_load_dwordx4 a[196:199], v1, s[48:49] offset:1024 sc1
ds_read_b128 a[16:19], v2 offset:31280
v_mfma_f32_16x16x32_bf16 v[24:27], a[144:147], a[4:7], v[24:27]
s_cmp_eq_u32 s60, 0
s_cselect_b32 s76, 0x3f2aaaab, -2.0
ds_read_b128 a[20:23], v2 offset:31296
v_mfma_f32_16x16x32_bf16 v[20:23], a[140:143], a[4:7], v[20:23]
ds_write_b128 v192, v[160:163] offset:656
v_mfma_f32_16x16x32_bf16 v[16:19], a[136:139], a[4:7], v[16:19]
s_waitcnt lgkmcnt(5)
v_mfma_f32_16x16x32_bf16 v[28:31], a[136:139], a[8:11], v[28:31]
global_load_dwordx4 a[200:203], v1, s[48:49] offset:2048 sc1
v_mfma_f32_16x16x32_bf16 v[32:35], a[140:143], a[8:11], v[32:35]
ds_write_b128 v192, v[164:167] offset:1296
v_mfma_f32_16x16x32_bf16 v[36:39], a[144:147], a[8:11], v[36:39]
s_waitcnt lgkmcnt(4)
v_mfma_f32_16x16x32_bf16 v[48:51], a[144:147], a[12:15], v[48:51]
global_load_dwordx4 a[204:207], v1, s[48:49] offset:3072 sc1
v_add_u32 v1, 0x2000, v1
v_mfma_f32_16x16x32_bf16 v[44:47], a[140:143], a[12:15], v[44:47]
ds_read_b128 a[24:27], v2 offset:33232
v_mfma_f32_16x16x32_bf16 v[40:43], a[136:139], a[12:15], v[40:43]
s_waitcnt vmcnt(14) lgkmcnt(4)
ds_read_b128 a[28:31], v2 offset:33216
v_mfma_f32_16x16x32_bf16 v[4:7], a[148:151], a[16:19], v[4:7]
s_waitcnt vmcnt(11) lgkmcnt(4)
ds_write_b128 v193, v[168:171] offset:640
v_mfma_f32_16x16x32_bf16 v[4:7], a[160:163], a[20:23], v[4:7]
s_waitcnt vmcnt(10)
global_load_dwordx4 a[208:211], v1, s[48:49] offset:-4096 sc1
v_mfma_f32_16x16x32_bf16 v[8:11], a[164:167], a[20:23], v[8:11]
s_mov_b32 s77, 0x40600000
s_cmp_eq_u32 s60, 0
s_cselect_b32 s77, 0xc0900000, s77
v_mfma_f32_16x16x32_bf16 v[8:11], a[152:155], a[16:19], v[8:11]
ds_write_b128 v193, v[172:175] offset:1280
v_mfma_f32_16x16x32_bf16 v[12:15], a[156:159], a[16:19], v[12:15]
s_waitcnt vmcnt(10)
global_load_dwordx4 a[212:215], v1, s[48:49] offset:-3072 sc1
v_mfma_f32_16x16x32_bf16 v[12:15], a[168:171], a[20:23], v[12:15]
s_waitcnt lgkmcnt(3)
v_mfma_f32_16x16x32_bf16 v[24:27], a[168:171], a[24:27], v[24:27]
s_waitcnt lgkmcnt(2)
ds_read_b128 a[0:3], v2 offset:35152
v_mfma_f32_16x16x32_bf16 v[24:27], a[156:159], a[28:31], v[24:27]
ds_read_b128 a[4:7], v2 offset:35168
global_load_dwordx4 a[216:219], v1, s[48:49] offset:-2048 sc1
v_mfma_f32_16x16x32_bf16 v[20:23], a[152:155], a[28:31], v[20:23]
ds_read_b128 a[8:11], v2 offset:37104
v_mfma_f32_16x16x32_bf16 v[20:23], a[164:167], a[24:27], v[20:23]
s_waitcnt lgkmcnt(3)
s_barrier
ds_read_b128 a[12:15], v2 offset:37088
v_mfma_f32_16x16x32_bf16 v[16:19], a[160:163], a[24:27], v[16:19]
v_mfma_f32_16x16x32_bf16 v[16:19], a[148:151], a[28:31], v[16:19]
s_waitcnt lgkmcnt(3)
global_load_dwordx4 a[220:223], v1, s[48:49] offset:-1024 sc1
v_mfma_f32_16x16x32_bf16 v[28:31], a[148:151], a[0:3], v[28:31]
s_waitcnt lgkmcnt(2)
ds_read_b128 a[16:19], v2 offset:31872
s_mov_b32 s78, 0x3f400000
v_mfma_f32_16x16x32_bf16 v[28:31], a[160:163], a[4:7], v[28:31]
s_mov_b32 s79, 0x3e800000
ds_write_b32 v3, v196 offset:0
v_mfma_f32_16x16x32_bf16 v[32:35], a[164:167], a[4:7], v[32:35]
s_mov_b32 s61, 0xbe000000
s_mov_b32 s70, -0.5
s_mov_b32 s72, s79
v_mfma_f32_16x16x32_bf16 v[32:35], a[152:155], a[0:3], v[32:35]
s_mul_i32 s26, s3, 12288
ds_read_b128 a[20:23], v2 offset:31888
global_load_dwordx4 a[224:227], v1, s[48:49] offset:0 sc1
v_mfma_f32_16x16x32_bf16 v[36:39], a[156:159], a[0:3], v[36:39]
s_xor_b32 s27, s3, 1
ds_write_b32 v3, v197 offset:4
v_mfma_f32_16x16x32_bf16 v[36:39], a[168:171], a[4:7], v[36:39]
s_waitcnt lgkmcnt(5)
s_mul_i32 s27, s27, 12288
s_sub_u32 s29, s26, s27
v_mfma_f32_16x16x32_bf16 v[48:51], a[168:171], a[8:11], v[48:51]
s_waitcnt lgkmcnt(4)
ds_read_b128 a[24:27], v2 offset:33824
s_add_u32 s28, s27, 52224
v_mfma_f32_16x16x32_bf16 v[48:51], a[156:159], a[12:15], v[48:51]
ds_write_b32 v3, v198 offset:8
v_mfma_f32_16x16x32_bf16 v[44:47], a[152:155], a[12:15], v[44:47]
global_load_dwordx4 a[228:231], v1, s[48:49] offset:1024 sc1
v_mbcnt_lo_u32_b32 v0, -1, 0
v_mfma_f32_16x16x32_bf16 v[44:47], a[164:167], a[8:11], v[44:47]
ds_read_b128 a[28:31], v2 offset:33808
v_mbcnt_hi_u32_b32 v0, -1, v0
v_mfma_f32_16x16x32_bf16 v[40:43], a[160:163], a[8:11], v[40:43]
ds_write_b32 v3, v199 offset:12
v_mfma_f32_16x16x32_bf16 v[40:43], a[148:151], a[12:15], v[40:43]
s_waitcnt vmcnt(14) lgkmcnt(7)
global_load_dwordx4 a[232:235], v1, s[48:49] offset:2048 sc1
v_lshl_add_u32 v0, v0, 2, s28
v_mfma_f32_16x16x32_bf16 v[4:7], a[172:175], a[16:19], v[4:7]
s_waitcnt vmcnt(12) lgkmcnt(5)
ds_read_b128 a[0:3], v2 offset:35744
s_mov_b32 m0, s26
v_mfma_f32_16x16x32_bf16 v[4:7], a[184:187], a[20:23], v[4:7]
s_waitcnt vmcnt(11)
ds_write_b32 v3, v200 offset:640
v_mfma_f32_16x16x32_bf16 v[8:11], a[188:191], a[20:23], v[8:11]
v_mfma_f32_16x16x32_bf16 v[8:11], a[176:179], a[16:19], v[8:11]
ds_read_b128 a[4:7], v2 offset:35760
global_load_dwordx4 a[236:239], v1, s[48:49] offset:3072 sc1
v_mfma_f32_16x16x32_bf16 v[12:15], a[180:183], a[16:19], v[12:15]
s_waitcnt vmcnt(11)
ds_write_b32 v3, v201 offset:644
v_mfma_f32_16x16x32_bf16 v[12:15], a[192:195], a[20:23], v[12:15]
s_waitcnt lgkmcnt(7)
L_stub0:
s_cbranch_execz L_body
v_mfma_f32_16x16x32_bf16 v[24:27], a[192:195], a[24:27], v[24:27]
s_waitcnt lgkmcnt(5)
ds_read_b128 a[8:11], v2 offset:37696
v_add_u32 v1, 0x2000, v1
v_mfma_f32_16x16x32_bf16 v[24:27], a[180:183], a[28:31], v[24:27]
ds_write_b32 v3, v202 offset:648
v_mfma_f32_16x16x32_bf16 v[20:23], a[176:179], a[28:31], v[20:23]
global_load_dwordx4 a[240:243], v1, s[48:49] offset:-4096 sc1
v_mfma_f32_16x16x32_bf16 v[20:23], a[188:191], a[24:27], v[20:23]
ds_read_b128 a[12:15], v2 offset:37680
v_mfma_f32_16x16x32_bf16 v[16:19], a[184:187], a[24:27], v[16:19]
ds_write_b32 v3, v203 offset:652
v_mfma_f32_16x16x32_bf16 v[16:19], a[172:175], a[28:31], v[16:19]
s_waitcnt lgkmcnt(7)
global_load_dwordx4 a[244:247], v1, s[48:49] offset:-3072 sc1
v_mfma_f32_16x16x32_bf16 v[28:31], a[172:175], a[0:3], v[28:31]
s_waitcnt lgkmcnt(5)
global_load_dword v134, v69, s[46:47] offset:160 sc1
ds_read_b128 a[16:19], v2 offset:31904
v_mfma_f32_16x16x32_bf16 v[28:31], a[184:187], a[4:7], v[28:31]
ds_write_b32 v3, v204 offset:1280
v_mfma_f32_16x16x32_bf16 v[32:35], a[188:191], a[4:7], v[32:35]
v_mfma_f32_16x16x32_bf16 v[32:35], a[176:179], a[0:3], v[32:35]
ds_read_b128 a[20:23], v2 offset:31920
global_load_dwordx4 a[248:251], v1, s[48:49] offset:-2048 sc1
v_mfma_f32_16x16x32_bf16 v[36:39], a[180:183], a[0:3], v[36:39]
ds_write_b32 v3, v205 offset:1284
v_mfma_f32_16x16x32_bf16 v[36:39], a[192:195], a[4:7], v[36:39]
s_waitcnt lgkmcnt(7)
v_mfma_f32_16x16x32_bf16 v[48:51], a[192:195], a[8:11], v[48:51]
s_waitcnt lgkmcnt(5)
ds_read_b128 a[24:27], v2 offset:33856
v_mfma_f32_16x16x32_bf16 v[48:51], a[180:183], a[12:15], v[48:51]
ds_write_b32 v3, v206 offset:1288
v_mfma_f32_16x16x32_bf16 v[44:47], a[176:179], a[12:15], v[44:47]
global_load_dwordx4 a[252:255], v1, s[48:49] offset:-1024 sc1
v_mfma_f32_16x16x32_bf16 v[44:47], a[188:191], a[8:11], v[44:47]
ds_read_b128 a[28:31], v2 offset:33840
v_mfma_f32_16x16x32_bf16 v[40:43], a[184:187], a[8:11], v[40:43]
ds_write_b32 v3, v207 offset:1292
v_mfma_f32_16x16x32_bf16 v[40:43], a[172:175], a[12:15], v[40:43]
s_waitcnt vmcnt(15) lgkmcnt(7)
global_load_dwordx4 a[112:115], v1, s[48:49] offset:0 sc1
v_mfma_f32_16x16x32_bf16 v[4:7], a[196:199], a[16:19], v[4:7]
s_waitcnt vmcnt(13) lgkmcnt(5)
ds_read_b128 a[0:3], v2 offset:35776
v_mfma_f32_16x16x32_bf16 v[4:7], a[208:211], a[20:23], v[4:7]
s_waitcnt vmcnt(12)
ds_write_b32 v3, v208 offset:16
v_mfma_f32_16x16x32_bf16 v[8:11], a[212:215], a[20:23], v[8:11]
v_mfma_f32_16x16x32_bf16 v[8:11], a[200:203], a[16:19], v[8:11]
ds_read_b128 a[4:7], v2 offset:35792
global_load_dwordx4 a[116:119], v1, s[48:49] offset:1024 sc1
v_mfma_f32_16x16x32_bf16 v[12:15], a[204:207], a[16:19], v[12:15]
s_waitcnt vmcnt(12)
ds_write_b32 v3, v209 offset:20
v_mfma_f32_16x16x32_bf16 v[12:15], a[216:219], a[20:23], v[12:15]
s_waitcnt lgkmcnt(7)
v_mfma_f32_16x16x32_bf16 v[24:27], a[216:219], a[24:27], v[24:27]
s_waitcnt lgkmcnt(5)
ds_read_b128 a[8:11], v2 offset:37728
v_mfma_f32_16x16x32_bf16 v[24:27], a[204:207], a[28:31], v[24:27]
ds_write_b32 v3, v210 offset:24
v_mfma_f32_16x16x32_bf16 v[20:23], a[200:203], a[28:31], v[20:23]
global_load_dwordx4 a[120:123], v1, s[48:49] offset:2048 sc1
v_mfma_f32_16x16x32_bf16 v[20:23], a[212:215], a[24:27], v[20:23]
ds_read_b128 a[12:15], v2 offset:37712
v_mfma_f32_16x16x32_bf16 v[16:19], a[208:211], a[24:27], v[16:19]
ds_write_b32 v3, v211 offset:28
v_mfma_f32_16x16x32_bf16 v[16:19], a[196:199], a[28:31], v[16:19]
s_waitcnt lgkmcnt(7)
global_load_dwordx4 a[124:127], v1, s[48:49] offset:3072 sc1
v_add_u32 v1, 0x2000, v1
v_mfma_f32_16x16x32_bf16 v[28:31], a[196:199], a[0:3], v[28:31]
s_waitcnt lgkmcnt(5)
ds_read_b128 a[16:19], v2 offset:31936
v_mfma_f32_16x16x32_bf16 v[28:31], a[208:211], a[4:7], v[28:31]
ds_write_b32 v3, v212 offset:656
v_mfma_f32_16x16x32_bf16 v[32:35], a[212:215], a[4:7], v[32:35]
v_mfma_f32_16x16x32_bf16 v[32:35], a[200:203], a[0:3], v[32:35]
ds_read_b128 a[20:23], v2 offset:32512
global_load_dwordx4 a[128:131], v1, s[48:49] offset:-4096 sc1
v_mfma_f32_16x16x32_bf16 v[36:39], a[204:207], a[0:3], v[36:39]
ds_write_b32 v3, v213 offset:660
v_mfma_f32_16x16x32_bf16 v[36:39], a[216:219], a[4:7], v[36:39]
s_waitcnt lgkmcnt(7)
v_mfma_f32_16x16x32_bf16 v[48:51], a[216:219], a[8:11], v[48:51]
s_waitcnt lgkmcnt(5)
ds_read_b128 a[24:27], v2 offset:32528
v_mfma_f32_16x16x32_bf16 v[48:51], a[204:207], a[12:15], v[48:51]
ds_write_b32 v3, v214 offset:664
v_mfma_f32_16x16x32_bf16 v[44:47], a[200:203], a[12:15], v[44:47]
global_load_dwordx4 a[132:135], v1, s[48:49] offset:-3072 sc1
v_mfma_f32_16x16x32_bf16 v[44:47], a[212:215], a[8:11], v[44:47]
ds_read_b128 a[28:31], v2 offset:34464
v_mfma_f32_16x16x32_bf16 v[40:43], a[208:211], a[8:11], v[40:43]
ds_write_b32 v3, v215 offset:668
v_mfma_f32_16x16x32_bf16 v[40:43], a[196:199], a[12:15], v[40:43]
s_waitcnt vmcnt(15) lgkmcnt(7)
global_load_dwordx4 a[136:139], v1, s[48:49] offset:-2048 sc1
v_mfma_f32_16x16x32_bf16 v[4:7], a[220:223], a[16:19], v[4:7]
s_waitcnt vmcnt(13) lgkmcnt(5)
ds_read_b128 a[0:3], v2 offset:34448
v_mfma_f32_16x16x32_bf16 v[4:7], a[232:235], a[20:23], v[4:7]
s_waitcnt vmcnt(10) lgkmcnt(4)
ds_write_b32 v3, v216 offset:1296
v_mfma_f32_16x16x32_bf16 v[4:7], a[244:247], a[24:27], v[4:7]
s_waitcnt vmcnt(8)
v_mfma_f32_16x16x32_bf16 v[8:11], a[248:251], a[24:27], v[8:11]
ds_read_b128 a[4:7], v2 offset:33872
global_load_dwordx4 a[140:143], v1, s[48:49] offset:-1024 sc1
v_mfma_f32_16x16x32_bf16 v[8:11], a[236:239], a[20:23], v[8:11]
ds_write_b32 v3, v217 offset:1300
v_mfma_f32_16x16x32_bf16 v[8:11], a[224:227], a[16:19], v[8:11]
v_cmp_eq_u32 vcc, 0, v134
v_mfma_f32_16x16x32_bf16 v[12:15], a[228:231], a[16:19], v[12:15]
ds_read_b128 a[8:11], v2 offset:35808
v_mfma_f32_16x16x32_bf16 v[12:15], a[240:243], a[20:23], v[12:15]
s_waitcnt vmcnt(8)
global_load_dwordx4 a[144:147], v1, s[48:49] offset:0 sc1
v_mfma_f32_16x16x32_bf16 v[12:15], a[252:255], a[24:27], v[12:15]
s_waitcnt lgkmcnt(6)
ds_write_b32 v3, v218 offset:1304
v_mfma_f32_16x16x32_bf16 v[24:27], a[252:255], a[28:31], v[24:27]
s_waitcnt lgkmcnt(5)
ds_read_b128 a[12:15], v2 offset:36384
v_mfma_f32_16x16x32_bf16 v[24:27], a[240:243], a[0:3], v[24:27]
s_waitcnt lgkmcnt(4)
ds_write_b32 v3, v219 offset:1308
v_mfma_f32_16x16x32_bf16 v[24:27], a[228:231], a[4:7], v[24:27]
s_cmp_lg_u64 vcc, 0
s_cbranch_scc1 L_late2
L_go2:
v_mfma_f32_16x16x32_bf16 v[20:23], a[224:227], a[4:7], v[20:23]
global_load_dwordx4 a[148:151], v1, s[48:49] offset:1024 sc1
ds_read_b128 a[16:19], v2 offset:36400
v_mfma_f32_16x16x32_bf16 v[20:23], a[236:239], a[0:3], v[20:23]
ds_write_b32 v194, v220 offset:0
v_mfma_f32_16x16x32_bf16 v[20:23], a[248:251], a[28:31], v[20:23]
v_mfma_f32_16x16x32_bf16 v[16:19], a[244:247], a[28:31], v[16:19]
ds_read_b128 a[20:23], v2 offset:38336
global_load_dwordx4 a[152:155], v1, s[48:49] offset:2048 sc1
v_mfma_f32_16x16x32_bf16 v[16:19], a[232:235], a[0:3], v[16:19]
ds_write_b32 v194, v221 offset:4
v_mfma_f32_16x16x32_bf16 v[16:19], a[220:223], a[4:7], v[16:19]
s_waitcnt lgkmcnt(7)
v_mfma_f32_16x16x32_bf16 v[28:31], a[220:223], a[8:11], v[28:31]
s_waitcnt lgkmcnt(5)
ds_read_b128 a[24:27], v2 offset:38320
v_mfma_f32_16x16x32_bf16 v[28:31], a[232:235], a[12:15], v[28:31]
s_waitcnt lgkmcnt(4)
global_load_dwordx4 a[156:159], v1, s[48:49] offset:3072 sc1
v_add_u32 v1, 0x2000, v1
v_mfma_f32_16x16x32_bf16 v[28:31], a[244:247], a[16:19], v[28:31]
ds_write_b32 v194, v222 offset:8
v_mfma_f32_16x16x32_bf16 v[32:35], a[248:251], a[16:19], v[32:35]
ds_read_b128 a[28:31], v2 offset:37744
v_mfma_f32_16x16x32_bf16 v[32:35], a[236:239], a[12:15], v[32:35]
ds_write_b32 v194, v223 offset:12
v_mfma_f32_16x16x32_bf16 v[32:35], a[224:227], a[8:11], v[32:35]
v_mfma_f32_16x16x32_bf16 v[36:39], a[228:231], a[8:11], v[36:39]
global_load_dwordx4 a[160:163], v1, s[48:49] offset:-4096 sc1
ds_read_b128 a[0:3], v2 offset:32544
v_mfma_f32_16x16x32_bf16 v[36:39], a[240:243], a[12:15], v[36:39]
ds_write_b32 v194, v224 offset:640
v_mfma_f32_16x16x32_bf16 v[36:39], a[252:255], a[16:19], v[36:39]
s_waitcnt lgkmcnt(7)
v_mfma_f32_16x16x32_bf16 v[48:51], a[252:255], a[20:23], v[48:51]
s_waitcnt lgkmcnt(5)
global_load_dwordx4 a[164:167], v1, s[48:49] offset:-3072 sc1
ds_read_b128 a[4:7], v2 offset:32560
v_mfma_f32_16x16x32_bf16 v[48:51], a[240:243], a[24:27], v[48:51]
s_waitcnt lgkmcnt(4)
ds_write_b32 v194, v225 offset:644
v_mfma_f32_16x16x32_bf16 v[48:51], a[228:231], a[28:31], v[48:51]
v_mfma_f32_16x16x32_bf16 v[44:47], a[224:227], a[28:31], v[44:47]
ds_read_b128 a[8:11], v2 offset:32576
v_mfma_f32_16x16x32_bf16 v[44:47], a[236:239], a[24:27], v[44:47]
ds_write_b32 v194, v226 offset:648
v_mfma_f32_16x16x32_bf16 v[44:47], a[248:251], a[20:23], v[44:47]
global_load_dwordx4 a[168:171], v1, s[48:49] offset:-2048 sc1
v_mfma_f32_16x16x32_bf16 v[40:43], a[244:247], a[20:23], v[40:43]
ds_read_b128 a[12:15], v2 offset:34512
v_mfma_f32_16x16x32_bf16 v[40:43], a[232:235], a[24:27], v[40:43]
ds_write_b32 v194, v227 offset:652
v_mfma_f32_16x16x32_bf16 v[40:43], a[220:223], a[28:31], v[40:43]
s_waitcnt vmcnt(14) lgkmcnt(7)
global_load_dwordx4 a[172:175], v1, s[48:49] offset:-1024 sc1
v_mfma_f32_16x16x32_bf16 v[4:7], a[112:115], a[0:3], v[4:7]
s_waitcnt vmcnt(12) lgkmcnt(5)
ds_read_b128 a[16:19], v2 offset:34496
v_mfma_f32_16x16x32_bf16 v[4:7], a[124:127], a[4:7], v[4:7]
s_waitcnt vmcnt(9) lgkmcnt(4)
ds_write_b32 v194, v228 offset:1280
v_mfma_f32_16x16x32_bf16 v[4:7], a[136:139], a[8:11], v[4:7]
s_waitcnt vmcnt(8)
v_mfma_f32_16x16x32_bf16 v[8:11], a[140:143], a[8:11], v[8:11]
ds_read_b128 a[20:23], v2 offset:34480
global_load_dwordx4 a[176:179], v1, s[48:49] offset:0 sc1
v_mfma_f32_16x16x32_bf16 v[8:11], a[128:131], a[4:7], v[8:11]
ds_write_b32 v194, v229 offset:1284
v_mfma_f32_16x16x32_bf16 v[8:11], a[116:119], a[0:3], v[8:11]
v_mfma_f32_16x16x32_bf16 v[12:15], a[120:123], a[0:3], v[12:15]
ds_read_b128 a[24:27], v2 offset:36416
v_mfma_f32_16x16x32_bf16 v[12:15], a[132:135], a[4:7], v[12:15]
s_waitcnt vmcnt(8)
global_load_dwordx4 a[180:183], v1, s[48:49] offset:1024 sc1
v_mfma_f32_16x16x32_bf16 v[12:15], a[144:147], a[8:11], v[12:15]
s_waitcnt lgkmcnt(6)
ds_write_b32 v194, v230 offset:1288
v_mfma_f32_16x16x32_bf16 v[24:27], a[144:147], a[12:15], v[24:27]
s_waitcnt lgkmcnt(5)
ds_read_b128 a[28:31], v2 offset:36432
v_mfma_f32_16x16x32_bf16 v[24:27], a[132:135], a[16:19], v[24:27]
s_waitcnt lgkmcnt(4)
ds_write_b32 v194, v231 offset:1292
v_mfma_f32_16x16x32_bf16 v[24:27], a[120:123], a[20:23], v[24:27]
v_mfma_f32_16x16x32_bf16 v[20:23], a[116:119], a[20:23], v[20:23]
global_load_dwordx4 a[184:187], v1, s[48:49] offset:2048 sc1
ds_read_b128 a[0:3], v2 offset:36448
v_mfma_f32_16x16x32_bf16 v[20:23], a[128:131], a[16:19], v[20:23]
ds_write_b32 v194, v232 offset:16
v_mfma_f32_16x16x32_bf16 v[20:23], a[140:143], a[12:15], v[20:23]
v_mfma_f32_16x16x32_bf16 v[16:19], a[136:139], a[12:15], v[16:19]
ds_read_b128 a[4:7], v2 offset:38384
global_load_dwordx4 a[188:191], v1, s[48:49] offset:3072 sc1
v_mfma_f32_16x16x32_bf16 v[16:19], a[124:127], a[16:19], v[16:19]
ds_write_b32 v194, v233 offset:20
v_mfma_f32_16x16x32_bf16 v[16:19], a[112:115], a[20:23], v[16:19]
s_waitcnt lgkmcnt(7)
v_add_u32 v1, 0x2000, v1
v_mfma_f32_16x16x32_bf16 v[28:31], a[112:115], a[24:27], v[28:31]
s_waitcnt lgkmcnt(5)
ds_read_b128 a[8:11], v2 offset:38368
v_mfma_f32_16x16x32_bf16 v[28:31], a[124:127], a[28:31], v[28:31]
s_waitcnt lgkmcnt(4)
global_load_dwordx4 a[192:195], v1, s[48:49] offset:-4096 sc1
v_mfma_f32_16x16x32_bf16 v[28:31], a[136:139], a[0:3], v[28:31]
ds_write_b32 v194, v234 offset:24
v_mfma_f32_16x16x32_bf16 v[32:35], a[140:143], a[0:3], v[32:35]
ds_read_b128 a[12:15], v2 offset:38352
v_mfma_f32_16x16x32_bf16 v[32:35], a[128:131], a[28:31], v[32:35]
ds_write_b32 v194, v235 offset:28
v_mfma_f32_16x16x32_bf16 v[32:35], a[116:119], a[24:27], v[32:35]
v_mfma_f32_16x16x32_bf16 v[36:39], a[120:123], a[24:27], v[36:39]
global_load_dwordx4 a[196:199], v1, s[48:49] offset:-3072 sc1
ds_read_b128 a[16:19], v2 offset:0
v_mfma_f32_16x16x32_bf16 v[36:39], a[132:135], a[28:31], v[36:39]
ds_write_b32 v194, v236 offset:656
v_mfma_f32_16x16x32_bf16 v[36:39], a[144:147], a[0:3], v[36:39]
s_waitcnt lgkmcnt(7)
v_mfma_f32_16x16x32_bf16 v[48:51], a[144:147], a[4:7], v[48:51]
s_waitcnt lgkmcnt(5)
global_load_dwordx4 a[200:203], v1, s[48:49] offset:-2048 sc1
ds_read_b128 a[20:23], v2 offset:16
v_mfma_f32_16x16x32_bf16 v[48:51], a[132:135], a[8:11], v[48:51]
s_waitcnt lgkmcnt(4)
ds_write_b32 v194, v237 offset:660
v_mfma_f32_16x16x32_bf16 v[48:51], a[120:123], a[12:15], v[48:51]
v_mfma_f32_16x16x32_bf16 v[44:47], a[116:119], a[12:15], v[44:47]
s_barrier
ds_read_b128 a[24:27], v2 offset:32
v_mfma_f32_16x16x32_bf16 v[44:47], a[128:131], a[8:11], v[44:47]
ds_write_b32 v194, v238 offset:664
v_mfma_f32_16x16x32_bf16 v[44:47], a[140:143], a[4:7], v[44:47]
global_load_dwordx4 a[204:207], v1, s[48:49] offset:-1024 sc1
v_mfma_f32_16x16x32_bf16 v[40:43], a[136:139], a[4:7], v[40:43]
ds_read_b128 a[28:31], v2 offset:1968
v_mfma_f32_16x16x32_bf16 v[40:43], a[124:127], a[8:11], v[40:43]
ds_write_b32 v194, v239 offset:668
v_mfma_f32_16x16x32_bf16 v[40:43], a[112:115], a[12:15], v[40:43]
s_waitcnt vmcnt(14) lgkmcnt(7)
global_load_dwordx4 a[208:211], v1, s[48:49] offset:0 sc1
v_mfma_f32_16x16x32_bf16 v[52:55], a[148:151], a[16:19], v[4:7]
s_waitcnt vmcnt(12) lgkmcnt(5)
ds_read_b128 a[0:3], v2 offset:1952
v_mfma_f32_16x16x32_bf16 v[52:55], a[160:163], a[20:23], v[52:55]
s_waitcnt vmcnt(9) lgkmcnt(4)
ds_write_b32 v194, v240 offset:1296
v_mfma_f32_16x16x32_bf16 v[52:55], a[172:175], a[24:27], v[52:55]
s_waitcnt vmcnt(8)
v_mfma_f32_16x16x32_bf16 v[56:59], a[176:179], a[24:27], v[8:11]
ds_read_b128 a[4:7], v2 offset:1936
global_load_dwordx4 a[212:215], v1, s[48:49] offset:1024 sc1
v_mfma_f32_16x16x32_bf16 v[56:59], a[164:167], a[20:23], v[56:59]
ds_write_b32 v194, v241 offset:1300
v_mfma_f32_16x16x32_bf16 v[56:59], a[152:155], a[16:19], v[56:59]
v_mfma_f32_16x16x32_bf16 v[60:63], a[156:159], a[16:19], v[12:15]
ds_read_b128 a[8:11], v2 offset:3872
v_mfma_f32_16x16x32_bf16 v[60:63], a[168:171], a[20:23], v[60:63]
s_waitcnt vmcnt(8)
global_load_dwordx4 a[216:219], v1, s[48:49] offset:2048 sc1
v_mfma_f32_16x16x32_bf16 v[60:63], a[180:183], a[24:27], v[60:63]
s_waitcnt lgkmcnt(6)
ds_write_b32 v194, v242 offset:1304
v_mfma_f32_16x16x32_bf16 v[72:75], a[180:183], a[28:31], v[24:27]
s_waitcnt lgkmcnt(5)
ds_read_b128 a[12:15], v2 offset:3888
v_mfma_f32_16x16x32_bf16 v[72:75], a[168:171], a[0:3], v[72:75]
s_waitcnt lgkmcnt(4)
ds_write_b32 v194, v243 offset:1308
v_mfma_f32_16x16x32_bf16 v[72:75], a[156:159], a[4:7], v[72:75]
v_mfma_f32_16x16x32_bf16 v[68:71], a[152:155], a[4:7], v[20:23]
global_load_dwordx4 a[220:223], v1, s[48:49] offset:3072 sc1
ds_read_b128 a[16:19], v2 offset:3904
v_mfma_f32_16x16x32_bf16 v[68:71], a[164:167], a[0:3], v[68:71]
ds_write_b32 v195, v244 offset:0
v_mfma_f32_16x16x32_bf16 v[68:71], a[176:179], a[28:31], v[68:71]
v_add_u32 v1, 0x2000, v1
v_mfma_f32_16x16x32_bf16 v[64:67], a[172:175], a[28:31], v[16:19]
ds_read_b128 a[20:23], v2 offset:5840
global_load_dwordx4 a[224:227], v1, s[48:49] offset:-4096 sc1
v_mfma_f32_16x16x32_bf16 v[64:67], a[160:163], a[0:3], v[64:67]
ds_write_b32 v195, v245 offset:4
v_mfma_f32_16x16x32_bf16 v[64:67], a[148:151], a[4:7], v[64:67]
s_waitcnt lgkmcnt(7)
v_mfma_f32_16x16x32_bf16 v[76:79], a[148:151], a[8:11], v[28:31]
s_waitcnt lgkmcnt(5)
ds_read_b128 a[24:27], v2 offset:5824
v_mfma_f32_16x16x32_bf16 v[76:79], a[160:163], a[12:15], v[76:79]
s_waitcnt lgkmcnt(4)
global_load_dwordx4 a[228:231], v1, s[48:49] offset:-3072 sc1
v_mfma_f32_16x16x32_bf16 v[76:79], a[172:175], a[16:19], v[76:79]
ds_write_b32 v195, v246 offset:8
v_mfma_f32_16x16x32_bf16 v[80:83], a[176:179], a[16:19], v[32:35]
ds_read_b128 a[28:31], v2 offset:5808
v_mfma_f32_16x16x32_bf16 v[80:83], a[164:167], a[12:15], v[80:83]
ds_write_b32 v195, v247 offset:12
v_mfma_f32_16x16x32_bf16 v[80:83], a[152:155], a[8:11], v[80:83]
v_mfma_f32_16x16x32_bf16 v[84:87], a[156:159], a[8:11], v[36:39]
global_load_dwordx4 a[232:235], v1, s[48:49] offset:-2048 sc1
ds_read_b128 a[0:3], v2 offset:48
v_mfma_f32_16x16x32_bf16 v[84:87], a[168:171], a[12:15], v[84:87]
ds_write_b32 v195, v248 offset:640
v_mfma_f32_16x16x32_bf16 v[84:87], a[180:183], a[16:19], v[84:87]
s_waitcnt lgkmcnt(7)
v_mfma_f32_16x16x32_bf16 v[96:99], a[180:183], a[20:23], v[48:51]
s_waitcnt lgkmcnt(5)
global_load_dwordx4 a[236:239], v1, s[48:49] offset:-1024 sc1
ds_read_b128 a[4:7], v2 offset:64
v_mfma_f32_16x16x32_bf16 v[96:99], a[168:171], a[24:27], v[96:99]
s_waitcnt lgkmcnt(4)
ds_write_b32 v195, v249 offset:644
v_mfma_f32_16x16x32_bf16 v[96:99], a[156:159], a[28:31], v[96:99]
v_mfma_f32_16x16x32_bf16 v[92:95], a[152:155], a[28:31], v[44:47]
ds_read_b128 a[8:11], v2 offset:640
v_mfma_f32_16x16x32_bf16 v[92:95], a[164:167], a[24:27], v[92:95]
ds_write_b32 v195, v250 offset:648
v_mfma_f32_16x16x32_bf16 v[92:95], a[176:179], a[20:23], v[92:95]
global_load_dwordx4 a[240:243], v1, s[48:49] offset:0 sc1
v_mfma_f32_16x16x32_bf16 v[88:91], a[172:175], a[20:23], v[40:43]
ds_read_b128 a[12:15], v2 offset:2576
v_mfma_f32_16x16x32_bf16 v[88:91], a[160:163], a[24:27], v[88:91]
ds_write_b32 v195, v251 offset:652
v_mfma_f32_16x16x32_bf16 v[88:91], a[148:151], a[28:31], v[88:91]
s_waitcnt vmcnt(14) lgkmcnt(7)
global_load_dwordx4 a[244:247], v1, s[48:49] offset:1024 sc1
v_mfma_f32_16x16x32_bf16 v[52:55], a[184:187], a[0:3], v[52:55]
s_waitcnt vmcnt(12) lgkmcnt(5)
ds_read_b128 a[16:19], v2 offset:2000
v_mfma_f32_16x16x32_bf16 v[52:55], a[196:199], a[4:7], v[52:55]
s_waitcnt vmcnt(9) lgkmcnt(4)
ds_write_b32 v195, v252 offset:1280
v_mfma_f32_16x16x32_bf16 v[52:55], a[208:211], a[8:11], v[52:55]
s_waitcnt vmcnt(8)
v_mfma_f32_16x16x32_bf16 v[56:59], a[212:215], a[8:11], v[56:59]
ds_read_b128 a[20:23], v2 offset:1984
global_load_dwordx4 a[248:251], v1, s[48:49] offset:2048 sc1
v_mfma_f32_16x16x32_bf16 v[56:59], a[200:203], a[4:7], v[56:59]
ds_write_b32 v195, v253 offset:1284
v_mfma_f32_16x16x32_bf16 v[56:59], a[188:191], a[0:3], v[56:59]
v_mfma_f32_16x16x32_bf16 v[60:63], a[192:195], a[0:3], v[60:63]
ds_read_b128 a[24:27], v2 offset:3920
v_mfma_f32_16x16x32_bf16 v[60:63], a[204:207], a[4:7], v[60:63]
s_waitcnt vmcnt(8)
global_load_dwordx4 a[252:255], v1, s[48:49] offset:3072 sc1
v_add_u32 v1, 0x2000, v1
v_mfma_f32_16x16x32_bf16 v[60:63], a[216:219], a[8:11], v[60:63]
s_waitcnt lgkmcnt(6)
ds_write_b32 v195, v254 offset:1288
v_mfma_f32_16x16x32_bf16 v[72:75], a[216:219], a[12:15], v[72:75]
s_waitcnt lgkmcnt(5)
ds_read_b128 a[28:31], v2 offset:3936
v_mfma_f32_16x16x32_bf16 v[72:75], a[204:207], a[16:19], v[72:75]
s_waitcnt lgkmcnt(4)
ds_write_b32 v195, v255 offset:1292
v_mfma_f32_16x16x32_bf16 v[72:75], a[192:195], a[20:23], v[72:75]
ds_write_addtid_b32 v4 offset:52224
global_load_dwordx4 a[112:115], v1, s[48:49] offset:-4096 sc1
v_mfma_f32_16x16x32_bf16 v[68:71], a[188:191], a[20:23], v[68:71]
ds_read_b128 a[0:3], v2 offset:4512
v_mfma_f32_16x16x32_bf16 v[68:71], a[200:203], a[16:19], v[68:71]
ds_write_addtid_b32 v5 offset:52480
v_mfma_f32_16x16x32_bf16 v[68:71], a[212:215], a[12:15], v[68:71]
ds_write_addtid_b32 v6 offset:52736
v_mfma_f32_16x16x32_bf16 v[64:67], a[208:211], a[12:15], v[64:67]
ds_read_b128 a[4:7], v2 offset:6448
global_load_dwordx4 a[116:119], v1, s[48:49] offset:-3072 sc1
v_mfma_f32_16x16x32_bf16 v[64:67], a[196:199], a[16:19], v[64:67]
ds_write_addtid_b32 v7 offset:52992
v_mfma_f32_16x16x32_bf16 v[64:67], a[184:187], a[20:23], v[64:67]
s_waitcnt lgkmcnt(9)
ds_write_addtid_b32 v8 offset:53248
v_mfma_f32_16x16x32_bf16 v[76:79], a[184:187], a[24:27], v[76:79]
s_waitcnt lgkmcnt(8)
ds_read_b128 a[8:11], v2 offset:5872
v_mfma_f32_16x16x32_bf16 v[76:79], a[196:199], a[28:31], v[76:79]
s_waitcnt lgkmcnt(6)
global_load_dwordx4 a[120:123], v1, s[48:49] offset:-2048 sc1
ds_write_addtid_b32 v9 offset:53504
v_mfma_f32_16x16x32_bf16 v[76:79], a[208:211], a[0:3], v[76:79]
ds_write_addtid_b32 v10 offset:53760
v_mfma_f32_16x16x32_bf16 v[80:83], a[212:215], a[0:3], v[80:83]
ds_read_b128 a[12:15], v2 offset:5856
v_mfma_f32_16x16x32_bf16 v[80:83], a[200:203], a[28:31], v[80:83]
ds_write_addtid_b32 v11 offset:54016
v_mfma_f32_16x16x32_bf16 v[80:83], a[188:191], a[24:27], v[80:83]
ds_write_addtid_b32 v12 offset:54272
global_load_dwordx4 a[124:127], v1, s[48:49] offset:-1024 sc1
v_mfma_f32_16x16x32_bf16 v[84:87], a[192:195], a[24:27], v[84:87]
ds_read_b128 a[16:19], v2 offset:656
v_mfma_f32_16x16x32_bf16 v[84:87], a[204:207], a[28:31], v[84:87]
ds_write_addtid_b32 v13 offset:54528
v_mfma_f32_16x16x32_bf16 v[84:87], a[216:219], a[0:3], v[84:87]
s_waitcnt lgkmcnt(10)
ds_write_addtid_b32 v14 offset:54784
v_mfma_f32_16x16x32_bf16 v[96:99], a[216:219], a[4:7], v[96:99]
s_waitcnt lgkmcnt(8)
global_load_dwordx4 a[128:131], v1, s[48:49] offset:0 sc1
ds_read_b128 a[20:23], v2 offset:672
v_mfma_f32_16x16x32_bf16 v[96:99], a[204:207], a[8:11], v[96:99]
s_waitcnt lgkmcnt(6)
ds_write_addtid_b32 v15 offset:55040
v_mfma_f32_16x16x32_bf16 v[96:99], a[192:195], a[12:15], v[96:99]
ds_write_addtid_b32 v16 offset:55296
v_mfma_f32_16x16x32_bf16 v[92:95], a[188:191], a[12:15], v[92:95]
ds_read_b128 a[24:27], v2 offset:688
v_mfma_f32_16x16x32_bf16 v[92:95], a[200:203], a[8:11], v[92:95]
ds_write_addtid_b32 v17 offset:55552
global_load_dwordx4 a[132:135], v1, s[48:49] offset:1024 sc1
v_mfma_f32_16x16x32_bf16 v[92:95], a[212:215], a[4:7], v[92:95]
ds_write_addtid_b32 v18 offset:55808
v_mfma_f32_16x16x32_bf16 v[88:91], a[208:211], a[4:7], v[88:91]
ds_read_b128 a[28:31], v2 offset:2624
v_mfma_f32_16x16x32_bf16 v[88:91], a[196:199], a[8:11], v[88:91]
ds_write_addtid_b32 v19 offset:56064
v_mfma_f32_16x16x32_bf16 v[88:91], a[184:187], a[12:15], v[88:91]
s_waitcnt vmcnt(14) lgkmcnt(10)
global_load_dwordx4 a[136:139], v1, s[48:49] offset:2048 sc1
ds_write_addtid_b32 v20 offset:56320
v_mfma_f32_16x16x32_bf16 v[52:55], a[220:223], a[16:19], v[52:55]
s_waitcnt vmcnt(12) lgkmcnt(8)
ds_read_b128 a[0:3], v2 offset:2608
v_mfma_f32_16x16x32_bf16 v[52:55], a[232:235], a[20:23], v[52:55]
s_waitcnt vmcnt(9) lgkmcnt(6)
ds_write_addtid_b32 v21 offset:56576
v_mfma_f32_16x16x32_bf16 v[52:55], a[244:247], a[24:27], v[52:55]
s_waitcnt vmcnt(8)
ds_write_addtid_b32 v22 offset:56832
v_mfma_f32_16x16x32_bf16 v[56:59], a[248:251], a[24:27], v[56:59]
ds_read_b128 a[4:7], v2 offset:2592
global_load_dwordx4 a[140:143], v1, s[48:49] offset:3072 sc1
v_mfma_f32_16x16x32_bf16 v[56:59], a[236:239], a[20:23], v[56:59]
ds_write_addtid_b32 v23 offset:57088
v_add_u32 v1, 0x2000, v1
v_mfma_f32_16x16x32_bf16 v[56:59], a[224:227], a[16:19], v[56:59]
ds_write_addtid_b32 v24 offset:57344
v_mfma_f32_16x16x32_bf16 v[60:63], a[228:231], a[16:19], v[60:63]
ds_read_b128 a[8:11], v2 offset:4528
v_mfma_f32_16x16x32_bf16 v[60:63], a[240:243], a[20:23], v[60:63]
s_waitcnt vmcnt(8)
global_load_dwordx4 a[144:147], v1, s[48:49] offset:-4096 sc1
ds_write_addtid_b32 v25 offset:57600
v_mfma_f32_16x16x32_bf16 v[60:63], a[252:255], a[24:27], v[60:63]
s_waitcnt lgkmcnt(10)
ds_write_addtid_b32 v26 offset:57856
v_mfma_f32_16x16x32_bf16 v[72:75], a[252:255], a[28:31], v[72:75]
s_waitcnt lgkmcnt(8)
ds_read_b128 a[12:15], v2 offset:4544
v_mfma_f32_16x16x32_bf16 v[72:75], a[240:243], a[0:3], v[72:75]
s_waitcnt lgkmcnt(6)
ds_write_addtid_b32 v27 offset:58112
v_mfma_f32_16x16x32_bf16 v[72:75], a[228:231], a[4:7], v[72:75]
ds_write_addtid_b32 v28 offset:58368
global_load_dwordx4 a[148:151], v1, s[48:49] offset:-3072 sc1
v_mfma_f32_16x16x32_bf16 v[68:71], a[224:227], a[4:7], v[68:71]
ds_read_b128 a[16:19], v2 offset:4560
v_mfma_f32_16x16x32_bf16 v[68:71], a[236:239], a[0:3], v[68:71]
ds_write_addtid_b32 v29 offset:58624
v_mfma_f32_16x16x32_bf16 v[68:71], a[248:251], a[28:31], v[68:71]
ds_write_addtid_b32 v30 offset:58880
v_mfma_f32_16x16x32_bf16 v[64:67], a[244:247], a[28:31], v[64:67]
ds_read_b128 a[20:23], v2 offset:6496
global_load_dwordx4 a[152:155], v1, s[48:49] offset:-2048 sc1
v_mfma_f32_16x16x32_bf16 v[64:67], a[232:235], a[0:3], v[64:67]
ds_write_addtid_b32 v31 offset:59136
v_mfma_f32_16x16x32_bf16 v[64:67], a[220:223], a[4:7], v[64:67]
s_waitcnt lgkmcnt(10)
ds_write_addtid_b32 v32 offset:59392
v_mfma_f32_16x16x32_bf16 v[76:79], a[220:223], a[8:11], v[76:79]
s_waitcnt lgkmcnt(8)
ds_read_b128 a[24:27], v2 offset:6480
v_mfma_f32_16x16x32_bf16 v[76:79], a[232:235], a[12:15], v[76:79]
s_waitcnt lgkmcnt(6)
global_load_dwordx4 a[156:159], v1, s[48:49] offset:-1024 sc1
ds_write_addtid_b32 v33 offset:59648
v_mfma_f32_16x16x32_bf16 v[76:79], a[244:247], a[16:19], v[76:79]
ds_write_addtid_b32 v34 offset:59904
v_mfma_f32_16x16x32_bf16 v[80:83], a[248:251], a[16:19], v[80:83]
ds_read_b128 a[28:31], v2 offset:6464
v_mfma_f32_16x16x32_bf16 v[80:83], a[236:239], a[12:15], v[80:83]
ds_write_addtid_b32 v35 offset:60160
v_mfma_f32_16x16x32_bf16 v[80:83], a[224:227], a[8:11], v[80:83]
ds_write_addtid_b32 v36 offset:60416
global_load_dwordx4 a[160:163], v1, s[48:49] offset:0 sc1
v_mfma_f32_16x16x32_bf16 v[84:87], a[228:231], a[8:11], v[84:87]
ds_read_b128 a[0:3], v2 offset:704
v_mfma_f32_16x16x32_bf16 v[84:87], a[240:243], a[12:15], v[84:87]
ds_write_addtid_b32 v37 offset:60672
v_mfma_f32_16x16x32_bf16 v[84:87], a[252:255], a[16:19], v[84:87]
s_waitcnt lgkmcnt(10)
ds_write_addtid_b32 v38 offset:60928
v_mfma_f32_16x16x32_bf16 v[96:99], a[252:255], a[20:23], v[96:99]
s_waitcnt lgkmcnt(8)
global_load_dwordx4 a[164:167], v1, s[48:49] offset:1024 sc1
ds_read_b128 a[4:7], v2 offset:1280
v_mfma_f32_16x16x32_bf16 v[96:99], a[240:243], a[24:27], v[96:99]
s_waitcnt lgkmcnt(6)
ds_write_addtid_b32 v39 offset:61184
v_mfma_f32_16x16x32_bf16 v[96:99], a[228:231], a[28:31], v[96:99]
ds_write_addtid_b32 v40 offset:61440
v_mfma_f32_16x16x32_bf16 v[92:95], a[224:227], a[28:31], v[92:95]
ds_read_b128 a[8:11], v2 offset:1296
v_mfma_f32_16x16x32_bf16 v[92:95], a[236:239], a[24:27], v[92:95]
ds_write_addtid_b32 v41 offset:61696
global_load_dwordx4 a[168:171], v1, s[48:49] offset:2048 sc1
v_mfma_f32_16x16x32_bf16 v[92:95], a[248:251], a[20:23], v[92:95]
ds_write_addtid_b32 v42 offset:61952
v_mfma_f32_16x16x32_bf16 v[88:91], a[244:247], a[20:23], v[88:91]
ds_read_b128 a[12:15], v2 offset:3232
v_mfma_f32_16x16x32_bf16 v[88:91], a[232:235], a[24:27], v[88:91]
ds_write_addtid_b32 v43 offset:62208
v_mfma_f32_16x16x32_bf16 v[88:91], a[220:223], a[28:31], v[88:91]
s_waitcnt vmcnt(14) lgkmcnt(10)
global_load_dwordx4 a[172:175], v1, s[48:49] offset:3072 sc1
ds_write_addtid_b32 v44 offset:62464
v_mfma_f32_16x16x32_bf16 v[52:55], a[112:115], a[0:3], v[52:55]
s_waitcnt vmcnt(12) lgkmcnt(8)
ds_read_b128 a[16:19], v2 offset:3216
v_add_u32 v1, 0x2000, v1
v_mfma_f32_16x16x32_bf16 v[52:55], a[124:127], a[4:7], v[52:55]
s_waitcnt vmcnt(9) lgkmcnt(6)
ds_write_addtid_b32 v45 offset:62720
v_mfma_f32_16x16x32_bf16 v[52:55], a[136:139], a[8:11], v[52:55]
s_waitcnt vmcnt(8)
ds_write_addtid_b32 v46 offset:62976
v_mfma_f32_16x16x32_bf16 v[56:59], a[140:143], a[8:11], v[56:59]
L_stub1:
s_cbranch_execz L_body
global_load_dwordx4 a[176:179], v1, s[48:49] offset:-4096 sc1
v_mfma_f32_16x16x32_bf16 v[56:59], a[128:131], a[4:7], v[56:59]
ds_read_b128 a[20:23], v2 offset:2640
v_mfma_f32_16x16x32_bf16 v[56:59], a[116:119], a[0:3], v[56:59]
ds_write_addtid_b32 v47 offset:63232
v_mfma_f32_16x16x32_bf16 v[60:63], a[120:123], a[0:3], v[60:63]
ds_read_b128 a[24:27], v2 offset:4576
v_mfma_f32_16x16x32_bf16 v[60:63], a[132:135], a[4:7], v[60:63]
s_waitcnt vmcnt(8)
global_load_dwordx4 a[180:183], v1, s[48:49] offset:-3072 sc1
ds_write_addtid_b32 v48 offset:63488
v_mfma_f32_16x16x32_bf16 v[60:63], a[144:147], a[8:11], v[60:63]
s_waitcnt lgkmcnt(9)
ds_write_addtid_b32 v49 offset:63744
v_mfma_f32_16x16x32_bf16 v[72:75], a[144:147], a[12:15], v[72:75]
s_waitcnt lgkmcnt(7)
ds_read_b128 a[28:31], v2 offset:5152
v_mfma_f32_16x16x32_bf16 v[72:75], a[132:135], a[16:19], v[72:75]
s_waitcnt lgkmcnt(5)
ds_write_addtid_b32 v50 offset:64000
v_mfma_f32_16x16x32_bf16 v[72:75], a[120:123], a[20:23], v[72:75]
ds_write_addtid_b32 v51 offset:64256
global_load_dwordx4 a[184:187], v1, s[48:49] offset:-2048 sc1
v_mfma_f32_16x16x32_bf16 v[68:71], a[116:119], a[20:23], v[68:71]
ds_read_b128 a[0:3], v2 offset:5168
v_mfma_f32_16x16x32_bf16 v[68:71], a[128:131], a[16:19], v[68:71]
v_mfma_f32_16x16x32_bf16 v[68:71], a[140:143], a[12:15], v[68:71]
s_waitcnt lgkmcnt(1)
s_barrier
v_mfma_f32_16x16x32_bf16 v[64:67], a[136:139], a[12:15], v[64:67]
ds_read_b128 a[4:7], v2 offset:7104
global_load_dwordx4 a[188:191], v1, s[48:49] offset:-1024 sc1
v_mfma_f32_16x16x32_bf16 v[64:67], a[124:127], a[16:19], v[64:67]
ds_read2st64_b32 v[148:149], v0 offset0:0 offset1:1
v_mfma_f32_16x16x32_bf16 v[64:67], a[112:115], a[20:23], v[64:67]
ds_read2st64_b32 v[150:151], v0 offset0:2 offset1:3
v_mfma_f32_16x16x32_bf16 v[76:79], a[112:115], a[24:27], v[76:79]
ds_read_b128 a[8:11], v2 offset:7088
v_mfma_f32_16x16x32_bf16 v[76:79], a[124:127], a[28:31], v[76:79]
s_waitcnt lgkmcnt(4)
global_load_dwordx4 a[192:195], v1, s[48:49] offset:0 sc1
ds_read2st64_b32 v[152:153], v0 offset0:4 offset1:5
v_mfma_f32_16x16x32_bf16 v[76:79], a[136:139], a[0:3], v[76:79]
ds_read2st64_b32 v[154:155], v0 offset0:6 offset1:7
v_mfma_f32_16x16x32_bf16 v[80:83], a[140:143], a[0:3], v[80:83]
ds_read_b128 a[12:15], v2 offset:6512
v_mfma_f32_16x16x32_bf16 v[80:83], a[128:131], a[28:31], v[80:83]
ds_read2st64_b32 v[156:157], v0 offset0:8 offset1:9
v_mfma_f32_16x16x32_bf16 v[80:83], a[116:119], a[24:27], v[80:83]
ds_read2st64_b32 v[158:159], v0 offset0:10 offset1:11
global_load_dwordx4 a[196:199], v1, s[48:49] offset:1024 sc1
v_mfma_f32_16x16x32_bf16 v[84:87], a[120:123], a[24:27], v[84:87]
ds_read_b128 a[16:19], v2 offset:1312
v_mfma_f32_16x16x32_bf16 v[84:87], a[132:135], a[28:31], v[84:87]
ds_read2st64_b32 v[160:161], v0 offset0:12 offset1:13
v_mfma_f32_16x16x32_bf16 v[84:87], a[144:147], a[0:3], v[84:87]
s_waitcnt lgkmcnt(10)
ds_read2st64_b32 v[162:163], v0 offset0:14 offset1:15
v_mfma_f32_16x16x32_bf16 v[96:99], a[144:147], a[4:7], v[96:99]
s_waitcnt lgkmcnt(8)
global_load_dwordx4 a[200:203], v1, s[48:49] offset:2048 sc1
ds_read_b128 a[20:23], v2 offset:1328
v_mfma_f32_16x16x32_bf16 v[96:99], a[132:135], a[8:11], v[96:99]
s_waitcnt lgkmcnt(6)
ds_read2st64_b32 v[164:165], v0 offset0:16 offset1:17
v_fma_f32 v4, v4, s76, v148
v_mfma_f32_16x16x32_bf16 v[96:99], a[120:123], a[12:15], v[96:99]
ds_read2st64_b32 v[166:167], v0 offset0:18 offset1:19
v_fma_f32 v5, v5, s76, v149
v_mfma_f32_16x16x32_bf16 v[92:95], a[116:119], a[12:15], v[92:95]
ds_read_b128 a[24:27], v2 offset:1344
v_fma_f32 v6, v6, s76, v150
v_mfma_f32_16x16x32_bf16 v[92:95], a[128:131], a[8:11], v[92:95]
ds_read2st64_b32 v[168:169], v0 offset0:20 offset1:21
global_load_dwordx4 a[204:207], v1, s[48:49] offset:3072 sc1
v_mfma_f32_16x16x32_bf16 v[92:95], a[140:143], a[4:7], v[92:95]
ds_read2st64_b32 v[170:171], v0 offset0:22 offset1:23
v_add_u32 v1, 0x2000, v1
v_mfma_f32_16x16x32_bf16 v[88:91], a[136:139], a[4:7], v[88:91]
ds_read_b128 a[28:31], v2 offset:3280
v_fma_f32 v7, v7, s76, v151
v_mfma_f32_16x16x32_bf16 v[88:91], a[124:127], a[8:11], v[88:91]
ds_read2st64_b32 v[172:173], v0 offset0:24 offset1:25
v_fma_f32 v8, v8, s76, v152
v_mfma_f32_16x16x32_bf16 v[88:91], a[112:115], a[12:15], v[88:91]
s_waitcnt vmcnt(14) lgkmcnt(10)
global_load_dwordx4 a[208:211], v1, s[48:49] offset:-4096 sc1
ds_read2st64_b32 v[174:175], v0 offset0:26 offset1:27
v_mfma_f32_16x16x32_bf16 v[52:55], a[148:151], a[16:19], v[52:55]
s_waitcnt vmcnt(12) lgkmcnt(8)
ds_read_b128 a[0:3], v2 offset:3264
v_fma_f32 v9, v9, s76, v153
v_mfma_f32_16x16x32_bf16 v[52:55], a[160:163], a[20:23], v[52:55]
s_waitcnt vmcnt(9) lgkmcnt(6)
ds_read2st64_b32 v[176:177], v0 offset0:28 offset1:29
v_fma_f32 v10, v10, s76, v154
v_mfma_f32_16x16x32_bf16 v[52:55], a[172:175], a[24:27], v[52:55]
s_waitcnt vmcnt(8)
ds_read2st64_b32 v[178:179], v0 offset0:30 offset1:31
v_fma_f32 v11, v11, s76, v155
v_mfma_f32_16x16x32_bf16 v[56:59], a[176:179], a[24:27], v[56:59]
ds_read_b128 a[4:7], v2 offset:3248
global_load_dwordx4 a[212:215], v1, s[48:49] offset:-3072 sc1
v_mfma_f32_16x16x32_bf16 v[56:59], a[164:167], a[20:23], v[56:59]
ds_read2st64_b32 v[180:181], v0 offset0:32 offset1:33
v_fma_f32 v12, v12, s76, v156
v_mfma_f32_16x16x32_bf16 v[56:59], a[152:155], a[16:19], v[56:59]
ds_read2st64_b32 v[182:183], v0 offset0:34 offset1:35
v_fma_f32 v13, v13, s76, v157
v_mfma_f32_16x16x32_bf16 v[60:63], a[156:159], a[16:19], v[60:63]
ds_read_b128 a[8:11], v2 offset:5184
v_fma_f32 v14, v14, s76, v158
v_mfma_f32_16x16x32_bf16 v[60:63], a[168:171], a[20:23], v[60:63]
s_waitcnt vmcnt(8)
global_load_dwordx4 a[216:219], v1, s[48:49] offset:-2048 sc1
ds_read2st64_b32 v[184:185], v0 offset0:36 offset1:37
v_mfma_f32_16x16x32_bf16 v[60:63], a[180:183], a[24:27], v[60:63]
s_waitcnt lgkmcnt(10)
ds_read2st64_b32 v[186:187], v0 offset0:38 offset1:39
v_fma_f32 v15, v15, s76, v159
v_mfma_f32_16x16x32_bf16 v[72:75], a[180:183], a[28:31], v[72:75]
s_waitcnt lgkmcnt(8)
ds_read_b128 a[12:15], v2 offset:5200
v_fma_f32 v16, v16, s76, v160
v_mfma_f32_16x16x32_bf16 v[72:75], a[168:171], a[0:3], v[72:75]
s_waitcnt lgkmcnt(6)
ds_read2st64_b32 v[188:189], v0 offset0:40 offset1:41
v_fma_f32 v17, v17, s76, v161
v_mfma_f32_16x16x32_bf16 v[72:75], a[156:159], a[4:7], v[72:75]
ds_read2st64_b32 v[190:191], v0 offset0:42 offset1:43
global_load_dwordx4 a[220:223], v1, s[48:49] offset:-1024 sc1
v_mfma_f32_16x16x32_bf16 v[68:71], a[152:155], a[4:7], v[68:71]
ds_read_b128 a[16:19], v2 offset:5216
v_fma_f32 v18, v18, s76, v162
v_mfma_f32_16x16x32_bf16 v[68:71], a[164:167], a[0:3], v[68:71]
ds_read2st64_b32 v[192:193], v0 offset0:44 offset1:45
v_fma_f32 v19, v19, s76, v163
v_mfma_f32_16x16x32_bf16 v[68:71], a[176:179], a[28:31], v[68:71]
ds_read2st64_b32 v[194:195], v0 offset0:46 offset1:47
v_fma_f32 v20, v20, s76, v164
v_mfma_f32_16x16x32_bf16 v[64:67], a[172:175], a[28:31], v[64:67]
ds_read_b128 a[20:23], v2 offset:7152
global_load_dwordx4 a[224:227], v1, s[48:49] offset:0 sc1
v_mfma_f32_16x16x32_bf16 v[64:67], a[160:163], a[0:3], v[64:67]
v_add_u32 v0, s29, v0
v_fma_f32 v21, v21, s76, v165
v_mfma_f32_16x16x32_bf16 v[64:67], a[148:151], a[4:7], v[64:67]
s_waitcnt lgkmcnt(9)
v_fma_f32 v22, v22, s76, v166
v_fma_f32 v23, v23, s76, v167
v_mfma_f32_16x16x32_bf16 v[76:79], a[148:151], a[8:11], v[76:79]
s_waitcnt lgkmcnt(6)
ds_read_b128 a[24:27], v2 offset:7136
v_fma_f32 v24, v24, s76, v168
v_mfma_f32_16x16x32_bf16 v[76:79], a[160:163], a[12:15], v[76:79]
s_waitcnt lgkmcnt(4)
global_load_dwordx4 a[228:231], v1, s[48:49] offset:1024 sc1
v_fma_f32 v25, v25, s76, v169
v_mfma_f32_16x16x32_bf16 v[76:79], a[172:175], a[16:19], v[76:79]
s_mov_b32 m0, s27
v_fma_f32 v26, v26, s76, v170
v_fma_f32 v27, v27, s76, v171
v_mfma_f32_16x16x32_bf16 v[80:83], a[176:179], a[16:19], v[80:83]
ds_read_b128 a[28:31], v2 offset:7120
v_add_u32 v2, 101376, v2
v_mfma_f32_16x16x32_bf16 v[80:83], a[164:167], a[12:15], v[80:83]
ds_write_addtid_b32 v52 offset:52224
v_fma_f32 v28, v28, s76, v172
v_mfma_f32_16x16x32_bf16 v[80:83], a[152:155], a[8:11], v[80:83]
ds_write_addtid_b32 v53 offset:52480
global_load_dwordx4 a[232:235], v1, s[48:49] offset:2048 sc1
v_mfma_f32_16x16x32_bf16 v[84:87], a[156:159], a[8:11], v[84:87]
ds_read_b128 a[0:3], v2 offset:0
v_fma_f32 v29, v29, s76, v173
v_mfma_f32_16x16x32_bf16 v[84:87], a[168:171], a[12:15], v[84:87]
ds_write_addtid_b32 v54 offset:52736
v_fma_f32 v30, v30, s76, v174
v_mfma_f32_16x16x32_bf16 v[84:87], a[180:183], a[16:19], v[84:87]
s_waitcnt lgkmcnt(6)
ds_write_addtid_b32 v55 offset:52992
v_fma_f32 v31, v31, s76, v175
v_mfma_f32_16x16x32_bf16 v[96:99], a[180:183], a[20:23], v[96:99]
s_waitcnt lgkmcnt(6)
global_load_dwordx4 a[236:239], v1, s[48:49] offset:3072 sc1
ds_read_b128 a[4:7], v2 offset:16
v_mfma_f32_16x16x32_bf16 v[96:99], a[168:171], a[24:27], v[96:99]
s_waitcnt lgkmcnt(6)
ds_write_addtid_b32 v56 offset:53248
v_add_u32 v1, 0x2000, v1
v_mfma_f32_16x16x32_bf16 v[96:99], a[156:159], a[28:31], v[96:99]
ds_write_addtid_b32 v57 offset:53504
v_fma_f32 v32, v32, s76, v176
v_mfma_f32_16x16x32_bf16 v[92:95], a[152:155], a[28:31], v[92:95]
ds_read_b128 a[8:11], v2 offset:32
v_fma_f32 v33, v33, s76, v177
v_mfma_f32_16x16x32_bf16 v[92:95], a[164:167], a[24:27], v[92:95]
ds_write_addtid_b32 v58 offset:53760
global_load_dwordx4 a[240:243], v1, s[48:49] offset:-4096 sc1
v_mfma_f32_16x16x32_bf16 v[92:95], a[176:179], a[20:23], v[92:95]
ds_write_addtid_b32 v59 offset:54016
v_fma_f32 v34, v34, s76, v178
v_mfma_f32_16x16x32_bf16 v[88:91], a[172:175], a[20:23], v[88:91]
ds_read_b128 a[12:15], v2 offset:1968
v_fma_f32 v35, v35, s76, v179
v_mfma_f32_16x16x32_bf16 v[88:91], a[160:163], a[24:27], v[88:91]
ds_write_addtid_b32 v60 offset:54272
v_fma_f32 v36, v36, s76, v180
v_mfma_f32_16x16x32_bf16 v[88:91], a[148:151], a[28:31], v[88:91]
s_waitcnt vmcnt(14) lgkmcnt(10)
global_load_dwordx4 a[244:247], v1, s[48:49] offset:-3072 sc1
ds_write_addtid_b32 v61 offset:54528
v_mfma_f32_16x16x32_bf16 v[100:103], a[184:187], a[0:3], v[52:55]
s_waitcnt vmcnt(12) lgkmcnt(8)
ds_read_b128 a[16:19], v2 offset:1952
v_fma_f32 v37, v37, s76, v181
v_mfma_f32_16x16x32_bf16 v[100:103], a[196:199], a[4:7], v[100:103]
s_waitcnt vmcnt(9) lgkmcnt(6)
ds_write_addtid_b32 v62 offset:54784
v_fma_f32 v38, v38, s76, v182
v_mfma_f32_16x16x32_bf16 v[100:103], a[208:211], a[8:11], v[100:103]
s_waitcnt vmcnt(8)
ds_write_addtid_b32 v63 offset:55040
v_fma_f32 v39, v39, s76, v183
v_mfma_f32_16x16x32_bf16 v[104:107], a[212:215], a[8:11], v[56:59]
ds_read_b128 a[20:23], v2 offset:1936
global_load_dwordx4 a[248:251], v1, s[48:49] offset:-2048 sc1
v_mfma_f32_16x16x32_bf16 v[104:107], a[200:203], a[4:7], v[104:107]
ds_write_addtid_b32 v64 offset:55296
v_fma_f32 v40, v40, s76, v184
v_mfma_f32_16x16x32_bf16 v[104:107], a[188:191], a[0:3], v[104:107]
ds_write_addtid_b32 v65 offset:55552
v_fma_f32 v41, v41, s76, v185
v_mfma_f32_16x16x32_bf16 v[108:111], a[192:195], a[0:3], v[60:63]
ds_read_b128 a[24:27], v2 offset:3872
v_fma_f32 v42, v42, s76, v186
v_mfma_f32_16x16x32_bf16 v[108:111], a[204:207], a[4:7], v[108:111]
s_waitcnt vmcnt(8)
global_load_dwordx4 a[252:255], v1, s[48:49] offset:-1024 sc1
ds_write_addtid_b32 v66 offset:55808
v_mfma_f32_16x16x32_bf16 v[108:111], a[216:219], a[8:11], v[108:111]
s_waitcnt lgkmcnt(10)
ds_write_addtid_b32 v67 offset:56064
v_fma_f32 v43, v43, s76, v187
v_mfma_f32_16x16x32_bf16 v[120:123], a[216:219], a[12:15], v[72:75]
s_waitcnt lgkmcnt(8)
ds_read_b128 a[28:31], v2 offset:3888
v_fma_f32 v44, v44, s76, v188
v_mfma_f32_16x16x32_bf16 v[120:123], a[204:207], a[16:19], v[120:123]
s_waitcnt lgkmcnt(6)
ds_write_addtid_b32 v68 offset:56320
v_fma_f32 v45, v45, s76, v189
v_mfma_f32_16x16x32_bf16 v[120:123], a[192:195], a[20:23], v[120:123]
ds_write_addtid_b32 v69 offset:56576
global_load_dwordx4 a[112:115], v1, s[48:49] offset:0 sc1
v_fma_f32 v46, v46, s76, v190
v_fma_f32 v47, v47, s76, v191
v_fma_f32 v48, v48, s76, v192
v_fma_f32 v49, v49, s76, v193
v_fma_f32 v50, v50, s76, v194
v_fma_f32 v51, v51, s76, v195
v_mfma_f32_16x16x32_bf16 v[116:119], a[188:191], a[20:23], v[68:71]
ds_read_b128 a[0:3], v2 offset:3904
v_fma_f32 v4, v4, s78, v52
v_mfma_f32_16x16x32_bf16 v[116:119], a[200:203], a[16:19], v[116:119]
ds_write_addtid_b32 v70 offset:56832
v_fma_f32 v5, v5, s78, v53
v_mfma_f32_16x16x32_bf16 v[116:119], a[212:215], a[12:15], v[116:119]
global_load_dwordx4 a[116:119], v1, s[48:49] offset:1024 sc1
ds_write_addtid_b32 v71 offset:57088
v_mfma_f32_16x16x32_bf16 v[112:115], a[208:211], a[12:15], v[64:67]
ds_read_b128 a[4:7], v2 offset:5840
v_fma_f32 v6, v6, s78, v54
v_mfma_f32_16x16x32_bf16 v[112:115], a[196:199], a[16:19], v[112:115]
ds_write_addtid_b32 v72 offset:57344
v_fma_f32 v7, v7, s78, v55
v_mfma_f32_16x16x32_bf16 v[112:115], a[184:187], a[20:23], v[112:115]
s_waitcnt lgkmcnt(10)
ds_write_addtid_b32 v73 offset:57600
v_fma_f32 v8, v8, s78, v56
v_mfma_f32_16x16x32_bf16 v[124:127], a[184:187], a[24:27], v[76:79]
s_waitcnt lgkmcnt(8)
global_load_dwordx4 a[120:123], v1, s[48:49] offset:2048 sc1
ds_read_b128 a[8:11], v2 offset:5824
v_mfma_f32_16x16x32_bf16 v[124:127], a[196:199], a[28:31], v[124:127]
s_waitcnt lgkmcnt(6)
ds_write_addtid_b32 v74 offset:57856
v_fma_f32 v9, v9, s78, v57
v_mfma_f32_16x16x32_bf16 v[124:127], a[208:211], a[0:3], v[124:127]
ds_write_addtid_b32 v75 offset:58112
v_fma_f32 v10, v10, s78, v58
v_mfma_f32_16x16x32_bf16 v[128:131], a[212:215], a[0:3], v[80:83]
ds_read_b128 a[12:15], v2 offset:5808
v_fma_f32 v11, v11, s78, v59
v_mfma_f32_16x16x32_bf16 v[128:131], a[200:203], a[28:31], v[128:131]
global_load_dwordx4 a[124:127], v1, s[48:49] offset:3072 sc1
ds_write_addtid_b32 v76 offset:58368
v_mfma_f32_16x16x32_bf16 v[128:131], a[188:191], a[24:27], v[128:131]
ds_write_addtid_b32 v77 offset:58624
v_add_u32 v1, 0x2000, v1
v_mfma_f32_16x16x32_bf16 v[132:135], a[192:195], a[24:27], v[84:87]
ds_read_b128 a[16:19], v2 offset:48
v_fma_f32 v12, v12, s78, v60
v_mfma_f32_16x16x32_bf16 v[132:135], a[204:207], a[28:31], v[132:135]
ds_write_addtid_b32 v78 offset:58880
v_fma_f32 v13, v13, s78, v61
v_mfma_f32_16x16x32_bf16 v[132:135], a[216:219], a[0:3], v[132:135]
s_waitcnt lgkmcnt(10)
global_load_dwordx4 a[128:131], v1, s[48:49] offset:-4096 sc1
ds_write_addtid_b32 v79 offset:59136
v_mfma_f32_16x16x32_bf16 v[144:147], a[216:219], a[4:7], v[96:99]
s_waitcnt lgkmcnt(8)
ds_read_b128 a[20:23], v2 offset:64
v_fma_f32 v14, v14, s78, v62
v_mfma_f32_16x16x32_bf16 v[144:147], a[204:207], a[8:11], v[144:147]
s_waitcnt lgkmcnt(6)
ds_write_addtid_b32 v80 offset:59392
v_fma_f32 v15, v15, s78, v63
v_mfma_f32_16x16x32_bf16 v[144:147], a[192:195], a[12:15], v[144:147]
ds_write_addtid_b32 v81 offset:59648
v_fma_f32 v16, v16, s78, v64
v_mfma_f32_16x16x32_bf16 v[140:143], a[188:191], a[12:15], v[92:95]
global_load_dwordx4 a[132:135], v1, s[48:49] offset:-3072 sc1
ds_read_b128 a[24:27], v2 offset:640
v_mfma_f32_16x16x32_bf16 v[140:143], a[200:203], a[8:11], v[140:143]
ds_write_addtid_b32 v82 offset:59904
v_fma_f32 v17, v17, s78, v65
v_mfma_f32_16x16x32_bf16 v[140:143], a[212:215], a[4:7], v[140:143]
ds_write_addtid_b32 v83 offset:60160
v_fma_f32 v18, v18, s78, v66
v_mfma_f32_16x16x32_bf16 v[136:139], a[208:211], a[4:7], v[88:91]
ds_read_b128 a[28:31], v2 offset:2576
v_fma_f32 v19, v19, s78, v67
v_mfma_f32_16x16x32_bf16 v[136:139], a[196:199], a[8:11], v[136:139]
global_load_dwordx4 a[136:139], v1, s[48:49] offset:-2048 sc1
ds_write_addtid_b32 v84 offset:60416
v_mfma_f32_16x16x32_bf16 v[136:139], a[184:187], a[12:15], v[136:139]
s_waitcnt vmcnt(15) lgkmcnt(10)
ds_write_addtid_b32 v85 offset:60672
v_fma_f32 v20, v20, s78, v68
v_mfma_f32_16x16x32_bf16 v[100:103], a[220:223], a[16:19], v[100:103]
s_waitcnt vmcnt(12) lgkmcnt(8)
ds_read_b128 a[0:3], v2 offset:2000
v_fma_f32 v21, v21, s78, v69
v_mfma_f32_16x16x32_bf16 v[100:103], a[232:235], a[20:23], v[100:103]
s_waitcnt vmcnt(9) lgkmcnt(6)
ds_write_addtid_b32 v86 offset:60928
v_fma_f32 v22, v22, s78, v70
v_mfma_f32_16x16x32_bf16 v[100:103], a[244:247], a[24:27], v[100:103]
s_waitcnt vmcnt(8)
global_load_dwordx4 a[140:143], v1, s[48:49] offset:-1024 sc1
ds_write_addtid_b32 v87 offset:61184
v_mfma_f32_16x16x32_bf16 v[104:107], a[248:251], a[24:27], v[104:107]
ds_read_b128 a[4:7], v2 offset:1984
v_fma_f32 v23, v23, s78, v71
v_mfma_f32_16x16x32_bf16 v[104:107], a[236:239], a[20:23], v[104:107]
ds_write_addtid_b32 v88 offset:61440
v_fma_f32 v24, v24, s78, v72
v_mfma_f32_16x16x32_bf16 v[104:107], a[224:227], a[16:19], v[104:107]
ds_write_addtid_b32 v89 offset:61696
v_fma_f32 v25, v25, s78, v73
v_mfma_f32_16x16x32_bf16 v[108:111], a[228:231], a[16:19], v[108:111]
global_load_dwordx4 a[144:147], v1, s[48:49] offset:0 sc1
ds_read_b128 a[8:11], v2 offset:3920
v_mfma_f32_16x16x32_bf16 v[108:111], a[240:243], a[20:23], v[108:111]
s_waitcnt vmcnt(9)
ds_write_addtid_b32 v90 offset:61952
v_fma_f32 v26, v26, s78, v74
v_mfma_f32_16x16x32_bf16 v[108:111], a[252:255], a[24:27], v[108:111]
s_waitcnt lgkmcnt(10)
ds_write_addtid_b32 v91 offset:62208
v_fma_f32 v27, v27, s78, v75
v_mfma_f32_16x16x32_bf16 v[120:123], a[252:255], a[28:31], v[120:123]
s_waitcnt lgkmcnt(8)
ds_read_b128 a[12:15], v2 offset:3936
v_fma_f32 v28, v28, s78, v76
v_mfma_f32_16x16x32_bf16 v[120:123], a[240:243], a[0:3], v[120:123]
s_waitcnt lgkmcnt(6)
global_load_dwordx4 a[148:151], v1, s[48:49] offset:1024 sc1
ds_write_addtid_b32 v92 offset:62464
v_mfma_f32_16x16x32_bf16 v[120:123], a[228:231], a[4:7], v[120:123]
ds_write_addtid_b32 v93 offset:62720
v_fma_f32 v29, v29, s78, v77
v_mfma_f32_16x16x32_bf16 v[116:119], a[224:227], a[4:7], v[116:119]
ds_read_b128 a[16:19], v2 offset:4512
v_fma_f32 v30, v30, s78, v78
v_mfma_f32_16x16x32_bf16 v[116:119], a[236:239], a[0:3], v[116:119]
ds_write_addtid_b32 v94 offset:62976
v_fma_f32 v31, v31, s78, v79
v_mfma_f32_16x16x32_bf16 v[116:119], a[248:251], a[28:31], v[116:119]
global_load_dwordx4 a[152:155], v1, s[48:49] offset:2048 sc1
ds_write_addtid_b32 v95 offset:63232
v_mfma_f32_16x16x32_bf16 v[112:115], a[244:247], a[28:31], v[112:115]
ds_read_b128 a[20:23], v2 offset:6448
v_fma_f32 v32, v32, s78, v80
v_mfma_f32_16x16x32_bf16 v[112:115], a[232:235], a[0:3], v[112:115]
ds_write_addtid_b32 v96 offset:63488
v_fma_f32 v33, v33, s78, v81
v_mfma_f32_16x16x32_bf16 v[112:115], a[220:223], a[4:7], v[112:115]
s_waitcnt lgkmcnt(10)
ds_write_addtid_b32 v97 offset:63744
v_fma_f32 v34, v34, s78, v82
v_mfma_f32_16x16x32_bf16 v[124:127], a[220:223], a[8:11], v[124:127]
s_waitcnt lgkmcnt(8)
global_load_dwordx4 a[156:159], v1, s[48:49] offset:3072 sc1
ds_read_b128 a[24:27], v2 offset:5872
v_mfma_f32_16x16x32_bf16 v[124:127], a[232:235], a[12:15], v[124:127]
s_waitcnt lgkmcnt(6)
ds_write_addtid_b32 v98 offset:64000
v_add_u32 v1, 0x2000, v1
v_mfma_f32_16x16x32_bf16 v[124:127], a[244:247], a[16:19], v[124:127]
ds_write_addtid_b32 v99 offset:64256
v_fma_f32 v35, v35, s78, v83
v_mfma_f32_16x16x32_bf16 v[128:131], a[248:251], a[16:19], v[128:131]
s_waitcnt lgkmcnt(0)
s_barrier
ds_read_b128 a[28:31], v2 offset:5856
v_mfma_f32_16x16x32_bf16 v[128:131], a[236:239], a[12:15], v[128:131]
global_load_dwordx4 a[160:163], v1, s[48:49] offset:-4096 sc1
v_fma_f32 v36, v36, s78, v84
v_mfma_f32_16x16x32_bf16 v[128:131], a[224:227], a[8:11], v[128:131]
ds_read2st64_b32 v[200:201], v0 offset0:0 offset1:1
v_fma_f32 v37, v37, s78, v85
v_mfma_f32_16x16x32_bf16 v[132:135], a[228:231], a[8:11], v[132:135]
ds_read_b128 a[0:3], v2 offset:656
v_fma_f32 v38, v38, s78, v86
v_mfma_f32_16x16x32_bf16 v[132:135], a[240:243], a[12:15], v[132:135]
ds_read2st64_b32 v[202:203], v0 offset0:2 offset1:3
v_fma_f32 v39, v39, s78, v87
v_mfma_f32_16x16x32_bf16 v[132:135], a[252:255], a[16:19], v[132:135]
global_load_dwordx4 a[164:167], v1, s[48:49] offset:-3072 sc1
ds_read2st64_b32 v[204:205], v0 offset0:4 offset1:5
v_mfma_f32_16x16x32_bf16 v[144:147], a[252:255], a[20:23], v[144:147]
ds_read_b128 a[4:7], v2 offset:672
v_fma_f32 v40, v40, s78, v88
v_mfma_f32_16x16x32_bf16 v[144:147], a[240:243], a[24:27], v[144:147]
s_waitcnt lgkmcnt(5)
ds_read2st64_b32 v[206:207], v0 offset0:6 offset1:7
v_fma_f32 v41, v41, s78, v89
v_mfma_f32_16x16x32_bf16 v[144:147], a[228:231], a[28:31], v[144:147]
ds_read2st64_b32 v[208:209], v0 offset0:8 offset1:9
v_fma_f32 v42, v42, s78, v90
v_mfma_f32_16x16x32_bf16 v[140:143], a[224:227], a[28:31], v[140:143]
global_load_dwordx4 a[168:171], v1, s[48:49] offset:-2048 sc1
ds_read_b128 a[8:11], v2 offset:688
v_mfma_f32_16x16x32_bf16 v[140:143], a[236:239], a[24:27], v[140:143]
ds_read2st64_b32 v[210:211], v0 offset0:10 offset1:11
v_fma_f32 v43, v43, s78, v91
v_mfma_f32_16x16x32_bf16 v[140:143], a[248:251], a[20:23], v[140:143]
ds_read2st64_b32 v[212:213], v0 offset0:12 offset1:13
v_fma_f32 v44, v44, s78, v92
v_mfma_f32_16x16x32_bf16 v[136:139], a[244:247], a[20:23], v[136:139]
ds_read_b128 a[12:15], v2 offset:2624
v_fma_f32 v45, v45, s78, v93
v_mfma_f32_16x16x32_bf16 v[136:139], a[232:235], a[24:27], v[136:139]
global_load_dwordx4 a[172:175], v1, s[48:49] offset:-1024 sc1
ds_read2st64_b32 v[214:215], v0 offset0:14 offset1:15
v_mfma_f32_16x16x32_bf16 v[136:139], a[220:223], a[28:31], v[136:139]
s_waitcnt vmcnt(15) lgkmcnt(10)
ds_read2st64_b32 v[216:217], v0 offset0:16 offset1:17
v_fma_f32 v46, v46, s78, v94
v_mfma_f32_16x16x32_bf16 v[100:103], a[112:115], a[0:3], v[100:103]
s_waitcnt vmcnt(12) lgkmcnt(8)
ds_read_b128 a[16:19], v2 offset:2608
v_fma_f32 v47, v47, s78, v95
v_mfma_f32_16x16x32_bf16 v[100:103], a[124:127], a[4:7], v[100:103]
s_waitcnt vmcnt(9) lgkmcnt(6)
ds_read2st64_b32 v[218:219], v0 offset0:18 offset1:19
v_fma_f32 v48, v48, s78, v96
v_mfma_f32_16x16x32_bf16 v[100:103], a[136:139], a[8:11], v[100:103]
s_waitcnt vmcnt(8)
global_load_dwordx4 a[176:179], v1, s[48:49] offset:0 sc1
ds_read2st64_b32 v[220:221], v0 offset0:20 offset1:21
v_mfma_f32_16x16x32_bf16 v[104:107], a[140:143], a[8:11], v[104:107]
ds_read_b128 a[20:23], v2 offset:2592
v_fma_f32 v49, v49, s78, v97
v_mfma_f32_16x16x32_bf16 v[104:107], a[128:131], a[4:7], v[104:107]
ds_read2st64_b32 v[222:223], v0 offset0:22 offset1:23
v_fma_f32 v50, v50, s78, v98
v_mfma_f32_16x16x32_bf16 v[104:107], a[116:119], a[0:3], v[104:107]
ds_read2st64_b32 v[224:225], v0 offset0:24 offset1:25
v_fma_f32 v51, v51, s78, v99
v_mfma_f32_16x16x32_bf16 v[108:111], a[120:123], a[0:3], v[108:111]
global_load_dwordx4 a[180:183], v1, s[48:49] offset:1024 sc1
ds_read_b128 a[24:27], v2 offset:4528
v_mfma_f32_16x16x32_bf16 v[108:111], a[132:135], a[4:7], v[108:111]
s_waitcnt vmcnt(9)
ds_read2st64_b32 v[226:227], v0 offset0:26 offset1:27
v_fma_f32 v148, v148, s77, v200
v_mfma_f32_16x16x32_bf16 v[108:111], a[144:147], a[8:11], v[108:111]
s_waitcnt lgkmcnt(10)
ds_read2st64_b32 v[228:229], v0 offset0:28 offset1:29
v_fma_f32 v149, v149, s77, v201
v_mfma_f32_16x16x32_bf16 v[120:123], a[144:147], a[12:15], v[120:123]
s_waitcnt lgkmcnt(8)
ds_read_b128 a[28:31], v2 offset:4544
v_fma_f32 v150, v150, s77, v202
v_mfma_f32_16x16x32_bf16 v[120:123], a[132:135], a[16:19], v[120:123]
s_waitcnt lgkmcnt(6)
global_load_dwordx4 a[184:187], v1, s[48:49] offset:2048 sc1
ds_read2st64_b32 v[230:231], v0 offset0:30 offset1:31
v_mfma_f32_16x16x32_bf16 v[120:123], a[120:123], a[20:23], v[120:123]
ds_read2st64_b32 v[232:233], v0 offset0:32 offset1:33
v_fma_f32 v151, v151, s77, v203
v_mfma_f32_16x16x32_bf16 v[116:119], a[116:119], a[20:23], v[116:119]
ds_read_b128 a[0:3], v2 offset:4560
v_fma_f32 v152, v152, s77, v204
v_mfma_f32_16x16x32_bf16 v[116:119], a[128:131], a[16:19], v[116:119]
ds_read2st64_b32 v[234:235], v0 offset0:34 offset1:35
v_fma_f32 v153, v153, s77, v205
v_mfma_f32_16x16x32_bf16 v[116:119], a[140:143], a[12:15], v[116:119]
global_load_dwordx4 a[188:191], v1, s[48:49] offset:3072 sc1
ds_read2st64_b32 v[236:237], v0 offset0:36 offset1:37
v_mfma_f32_16x16x32_bf16 v[112:115], a[136:139], a[12:15], v[112:115]
ds_read_b128 a[4:7], v2 offset:6496
v_add_u32 v1, 0x2000, v1
v_mfma_f32_16x16x32_bf16 v[112:115], a[124:127], a[16:19], v[112:115]
ds_read2st64_b32 v[238:239], v0 offset0:38 offset1:39
v_fma_f32 v154, v154, s77, v206
v_mfma_f32_16x16x32_bf16 v[112:115], a[112:115], a[20:23], v[112:115]
s_waitcnt lgkmcnt(10)
ds_read2st64_b32 v[240:241], v0 offset0:40 offset1:41
v_fma_f32 v155, v155, s77, v207
v_mfma_f32_16x16x32_bf16 v[124:127], a[112:115], a[24:27], v[124:127]
s_waitcnt lgkmcnt(8)
global_load_dwordx4 a[192:195], v1, s[48:49] offset:-4096 sc1
ds_read_b128 a[8:11], v2 offset:6480
v_mfma_f32_16x16x32_bf16 v[124:127], a[124:127], a[28:31], v[124:127]
s_waitcnt lgkmcnt(6)
ds_read2st64_b32 v[242:243], v0 offset0:42 offset1:43
v_fma_f32 v156, v156, s77, v208
v_mfma_f32_16x16x32_bf16 v[124:127], a[136:139], a[0:3], v[124:127]
ds_read2st64_b32 v[244:245], v0 offset0:44 offset1:45
v_fma_f32 v157, v157, s77, v209
v_mfma_f32_16x16x32_bf16 v[128:131], a[140:143], a[0:3], v[128:131]
ds_read_b128 a[12:15], v2 offset:6464
v_fma_f32 v158, v158, s77, v210
v_mfma_f32_16x16x32_bf16 v[128:131], a[128:131], a[28:31], v[128:131]
global_load_dwordx4 a[196:199], v1, s[48:49] offset:-3072 sc1
ds_read2st64_b32 v[246:247], v0 offset0:46 offset1:47
v_mfma_f32_16x16x32_bf16 v[128:131], a[116:119], a[24:27], v[128:131]
v_mbcnt_lo_u32_b32 v196, -1, 0
v_mbcnt_hi_u32_b32 v196, -1, v196
v_mfma_f32_16x16x32_bf16 v[132:135], a[120:123], a[24:27], v[132:135]
L_stub2:
s_cbranch_execz L_body
ds_read_b128 a[16:19], v2 offset:704
v_mfma_f32_16x16x32_bf16 v[132:135], a[132:135], a[28:31], v[132:135]
v_lshl_add_u32 v0, v196, 4, s28
v_add_u32 v3, s29, v0
v_mfma_f32_16x16x32_bf16 v[132:135], a[144:147], a[0:3], v[132:135]
s_waitcnt lgkmcnt(8)
global_load_dwordx4 a[200:203], v1, s[48:49] offset:-2048 sc1
v_fma_f32 v159, v159, s77, v211
v_mfma_f32_16x16x32_bf16 v[144:147], a[144:147], a[4:7], v[144:147]
s_waitcnt lgkmcnt(5)
ds_read_b128 a[20:23], v2 offset:1280
v_fma_f32 v160, v160, s77, v212
v_mfma_f32_16x16x32_bf16 v[144:147], a[132:135], a[8:11], v[144:147]
s_waitcnt lgkmcnt(3)
v_fma_f32 v161, v161, s77, v213
v_fma_f32 v162, v162, s77, v214
v_mfma_f32_16x16x32_bf16 v[144:147], a[120:123], a[12:15], v[144:147]
v_fma_f32 v163, v163, s77, v215
v_fma_f32 v164, v164, s77, v216
v_mfma_f32_16x16x32_bf16 v[140:143], a[116:119], a[12:15], v[140:143]
global_load_dwordx4 a[204:207], v1, s[48:49] offset:-1024 sc1
ds_read_b128 a[24:27], v2 offset:1296
v_mfma_f32_16x16x32_bf16 v[140:143], a[128:131], a[8:11], v[140:143]
v_fma_f32 v165, v165, s77, v217
v_fma_f32 v166, v166, s77, v218
v_mfma_f32_16x16x32_bf16 v[140:143], a[140:143], a[4:7], v[140:143]
v_fma_f32 v167, v167, s77, v219
v_fma_f32 v168, v168, s77, v220
v_mfma_f32_16x16x32_bf16 v[136:139], a[136:139], a[4:7], v[136:139]
ds_read_b128 a[28:31], v2 offset:3232
v_fma_f32 v169, v169, s77, v221
v_mfma_f32_16x16x32_bf16 v[136:139], a[124:127], a[8:11], v[136:139]
global_load_dwordx4 a[208:211], v1, s[48:49] offset:0 sc1
v_fma_f32 v170, v170, s77, v222
v_mfma_f32_16x16x32_bf16 v[136:139], a[112:115], a[12:15], v[136:139]
s_waitcnt vmcnt(15) lgkmcnt(3)
v_fma_f32 v171, v171, s77, v223
v_fma_f32 v172, v172, s77, v224
v_mfma_f32_16x16x32_bf16 v[100:103], a[148:151], a[16:19], v[100:103]
s_waitcnt vmcnt(12) lgkmcnt(2)
ds_read_b128 a[0:3], v2 offset:3216
v_fma_f32 v173, v173, s77, v225
v_mfma_f32_16x16x32_bf16 v[100:103], a[160:163], a[20:23], v[100:103]
s_waitcnt vmcnt(9) lgkmcnt(2)
v_fma_f32 v174, v174, s77, v226
v_fma_f32 v175, v175, s77, v227
v_mfma_f32_16x16x32_bf16 v[100:103], a[172:175], a[24:27], v[100:103]
s_waitcnt vmcnt(8)
global_load_dwordx4 a[212:215], v1, s[48:49] offset:1024 sc1
v_fma_f32 v176, v176, s77, v228
v_mfma_f32_16x16x32_bf16 v[104:107], a[176:179], a[24:27], v[104:107]
ds_read_b128 a[4:7], v2 offset:2640
v_fma_f32 v177, v177, s77, v229
v_mfma_f32_16x16x32_bf16 v[104:107], a[164:167], a[20:23], v[104:107]
v_fma_f32 v178, v178, s77, v230
v_fma_f32 v179, v179, s77, v231
v_mfma_f32_16x16x32_bf16 v[104:107], a[152:155], a[16:19], v[104:107]
v_fma_f32 v180, v180, s77, v232
v_fma_f32 v181, v181, s77, v233
v_mfma_f32_16x16x32_bf16 v[108:111], a[156:159], a[16:19], v[108:111]
global_load_dwordx4 a[216:219], v1, s[48:49] offset:2048 sc1
ds_read_b128 a[8:11], v2 offset:4576
v_mfma_f32_16x16x32_bf16 v[108:111], a[168:171], a[20:23], v[108:111]
s_waitcnt vmcnt(9)
v_fma_f32 v182, v182, s77, v234
v_fma_f32 v183, v183, s77, v235
v_mfma_f32_16x16x32_bf16 v[108:111], a[180:183], a[24:27], v[108:111]
s_waitcnt lgkmcnt(3)
v_fma_f32 v184, v184, s77, v236
v_fma_f32 v185, v185, s77, v237
v_mfma_f32_16x16x32_bf16 v[120:123], a[180:183], a[28:31], v[120:123]
s_waitcnt lgkmcnt(2)
ds_read_b128 a[12:15], v2 offset:5152
v_fma_f32 v186, v186, s77, v238
v_mfma_f32_16x16x32_bf16 v[120:123], a[168:171], a[0:3], v[120:123]
s_waitcnt lgkmcnt(2)
global_load_dwordx4 a[220:223], v1, s[48:49] offset:3072 sc1
v_add_u32 v1, 0x2000, v1
v_mfma_f32_16x16x32_bf16 v[120:123], a[156:159], a[4:7], v[120:123]
v_fma_f32 v187, v187, s77, v239
v_fma_f32 v188, v188, s77, v240
v_mfma_f32_16x16x32_bf16 v[116:119], a[152:155], a[4:7], v[116:119]
ds_read_b128 a[16:19], v2 offset:5168
v_fma_f32 v189, v189, s77, v241
v_mfma_f32_16x16x32_bf16 v[116:119], a[164:167], a[0:3], v[116:119]
v_fma_f32 v190, v190, s77, v242
v_fma_f32 v191, v191, s77, v243
v_mfma_f32_16x16x32_bf16 v[116:119], a[176:179], a[28:31], v[116:119]
global_load_dwordx4 a[224:227], v1, s[48:49] offset:-4096 sc1
v_fma_f32 v192, v192, s77, v244
v_mfma_f32_16x16x32_bf16 v[112:115], a[172:175], a[28:31], v[112:115]
ds_read_b128 a[20:23], v2 offset:7104
v_fma_f32 v193, v193, s77, v245
v_mfma_f32_16x16x32_bf16 v[112:115], a[160:163], a[0:3], v[112:115]
v_fma_f32 v194, v194, s77, v246
v_fma_f32 v195, v195, s77, v247
v_mfma_f32_16x16x32_bf16 v[112:115], a[148:151], a[4:7], v[112:115]
s_waitcnt lgkmcnt(3)
v_and_b32 v197, 15, v196
v_mul_u32_u24 v197, 3088, v197
v_mfma_f32_16x16x32_bf16 v[124:127], a[148:151], a[8:11], v[124:127]
s_waitcnt lgkmcnt(2)
global_load_dwordx4 a[228:231], v1, s[48:49] offset:-3072 sc1
ds_read_b128 a[24:27], v2 offset:7088
v_mfma_f32_16x16x32_bf16 v[124:127], a[160:163], a[12:15], v[124:127]
s_waitcnt lgkmcnt(2)
v_lshrrev_b32 v248, 4, v196
v_lshl_add_u32 v197, v248, 3, v197
v_mfma_f32_16x16x32_bf16 v[124:127], a[172:175], a[16:19], v[124:127]
s_lshr_b32 s30, s3, 1
s_mul_i32 s30, s30, 96
s_mul_i32 s31, s60, 192
v_mfma_f32_16x16x32_bf16 v[128:131], a[176:179], a[16:19], v[128:131]
s_add_u32 s30, s30, s31
ds_read_b128 a[28:31], v2 offset:6512
s_add_u32 s32, s30, 192
v_mfma_f32_16x16x32_bf16 v[128:131], a[164:167], a[12:15], v[128:131]
global_load_dwordx4 a[232:235], v1, s[48:49] offset:-2048 sc1
v_add_u32 v198, s32, v197
v_mfma_f32_16x16x32_bf16 v[128:131], a[152:155], a[8:11], v[128:131]
s_lshl1_add_u32 s30, s31, s30
v_add_u32 v197, s30, v197
v_mul_u32_u24 v199, 2832, v248
v_mfma_f32_16x16x32_bf16 v[132:135], a[156:159], a[8:11], v[132:135]
ds_read_b128 a[0:3], v2 offset:1312
v_lshl_add_u32 v199, v196, 4, v199
v_mfma_f32_16x16x32_bf16 v[132:135], a[168:171], a[12:15], v[132:135]
s_mul_i32 s30, s3, 12352
v_add_u32 v199, s30, v199
v_mul_u32_u24 v248, 42752, v248
v_mfma_f32_16x16x32_bf16 v[132:135], a[180:183], a[16:19], v[132:135]
s_waitcnt lgkmcnt(3)
global_load_dwordx4 a[236:239], v1, s[48:49] offset:-1024 sc1
v_lshl_add_u32 v248, v196, 4, v248
v_mfma_f32_16x16x32_bf16 v[144:147], a[180:183], a[20:23], v[144:147]
s_waitcnt lgkmcnt(2)
ds_read_b128 a[4:7], v2 offset:1328
s_lshl2_add_u32 s30, s3, s24
v_mfma_f32_16x16x32_bf16 v[144:147], a[168:171], a[24:27], v[144:147]
s_waitcnt lgkmcnt(2)
s_mul_i32 s30, s30, 43008
s_add_u32 s30, s30, s25
v_mfma_f32_16x16x32_bf16 v[144:147], a[156:159], a[28:31], v[144:147]
v_add_u32 v248, s30, v248
v_mfma_f32_16x16x32_bf16 v[140:143], a[152:155], a[28:31], v[140:143]
global_load_dwordx4 a[240:243], v1, s[48:49] offset:0 sc1
ds_read_b128 a[8:11], v2 offset:1344
v_mfma_f32_16x16x32_bf16 v[140:143], a[164:167], a[24:27], v[140:143]
v_mfma_f32_16x16x32_bf16 v[140:143], a[176:179], a[20:23], v[140:143]
v_mfma_f32_16x16x32_bf16 v[136:139], a[172:175], a[20:23], v[136:139]
ds_read_b128 a[12:15], v2 offset:3280
v_mfma_f32_16x16x32_bf16 v[136:139], a[160:163], a[24:27], v[136:139]
global_load_dwordx4 a[244:247], v1, s[48:49] offset:1024 sc1
v_mfma_f32_16x16x32_bf16 v[136:139], a[148:151], a[28:31], v[136:139]
s_waitcnt vmcnt(15) lgkmcnt(3)
v_mfma_f32_16x16x32_bf16 v[100:103], a[184:187], a[0:3], v[100:103]
s_waitcnt vmcnt(12) lgkmcnt(2)
ds_read_b128 a[16:19], v2 offset:3264
v_mfma_f32_16x16x32_bf16 v[100:103], a[196:199], a[4:7], v[100:103]
s_waitcnt vmcnt(9) lgkmcnt(2)
v_mfma_f32_16x16x32_bf16 v[100:103], a[208:211], a[8:11], v[100:103]
s_waitcnt vmcnt(8)
global_load_dwordx4 a[248:251], v1, s[48:49] offset:2048 sc1
v_mfma_f32_16x16x32_bf16 v[104:107], a[212:215], a[8:11], v[104:107]
ds_read_b128 a[20:23], v2 offset:3248
v_mfma_f32_16x16x32_bf16 v[104:107], a[200:203], a[4:7], v[104:107]
v_mfma_f32_16x16x32_bf16 v[104:107], a[188:191], a[0:3], v[104:107]
v_mfma_f32_16x16x32_bf16 v[108:111], a[192:195], a[0:3], v[108:111]
global_load_dwordx4 a[252:255], v1, s[48:49] offset:3072 sc1
ds_read_b128 a[24:27], v2 offset:5184
v_mfma_f32_16x16x32_bf16 v[108:111], a[204:207], a[4:7], v[108:111]
s_waitcnt vmcnt(9)
ds_write_b128 v3, v[100:103] offset:0
v_pk_fma_f32 v[4:5], v[100:101], s[70:71], v[4:5] op_sel_hi:[1,0,1]
v_pk_fma_f32 v[6:7], v[102:103], s[70:71], v[6:7] op_sel_hi:[1,0,1]
v_mfma_f32_16x16x32_bf16 v[108:111], a[216:219], a[8:11], v[108:111]
s_waitcnt lgkmcnt(4)
v_add_u32 v1, 0x2000, v1
v_fma_f32 v148, v148, s79, v100
v_mfma_f32_16x16x32_bf16 v[120:123], a[216:219], a[12:15], v[120:123]
s_waitcnt lgkmcnt(3)
global_load_dwordx4 a[112:115], v1, s[48:49] offset:-4096 sc1
ds_read_b128 a[28:31], v2 offset:5200
v_mfma_f32_16x16x32_bf16 v[120:123], a[204:207], a[16:19], v[120:123]
s_waitcnt lgkmcnt(3)
ds_write_b128 v3, v[104:107] offset:1024
v_pk_fma_f32 v[8:9], v[104:105], s[70:71], v[8:9] op_sel_hi:[1,0,1]
v_pk_fma_f32 v[10:11], v[106:107], s[70:71], v[10:11] op_sel_hi:[1,0,1]
v_mfma_f32_16x16x32_bf16 v[120:123], a[192:195], a[20:23], v[120:123]
v_fma_f32 v149, v149, s79, v101
v_fma_f32 v150, v150, s79, v102
v_mfma_f32_16x16x32_bf16 v[116:119], a[188:191], a[20:23], v[116:119]
global_load_dwordx4 a[116:119], v1, s[48:49] offset:-3072 sc1
ds_read_b128 a[0:3], v2 offset:5216
v_mfma_f32_16x16x32_bf16 v[116:119], a[200:203], a[16:19], v[116:119]
ds_write_b128 v3, v[108:111] offset:2048
v_pk_fma_f32 v[12:13], v[108:109], s[70:71], v[12:13] op_sel_hi:[1,0,1]
v_pk_fma_f32 v[14:15], v[110:111], s[70:71], v[14:15] op_sel_hi:[1,0,1]
v_mfma_f32_16x16x32_bf16 v[116:119], a[212:215], a[12:15], v[116:119]
global_load_dwordx4 a[120:123], v1, s[48:49] offset:-2048 sc1
v_fma_f32 v151, v151, s79, v103
v_mfma_f32_16x16x32_bf16 v[112:115], a[208:211], a[12:15], v[112:115]
ds_read_b128 a[4:7], v2 offset:7152
v_fma_f32 v152, v152, s79, v104
v_mfma_f32_16x16x32_bf16 v[112:115], a[196:199], a[16:19], v[112:115]
ds_write_b128 v3, v[120:123] offset:5120
v_pk_fma_f32 v[24:25], v[120:121], s[70:71], v[24:25] op_sel_hi:[1,0,1]
v_pk_fma_f32 v[26:27], v[122:123], s[70:71], v[26:27] op_sel_hi:[1,0,1]
v_mfma_f32_16x16x32_bf16 v[112:115], a[184:187], a[20:23], v[112:115]
s_waitcnt lgkmcnt(7)
global_load_dwordx4 a[124:127], v1, s[48:49] offset:-1024 sc1
v_fma_f32 v153, v153, s79, v105
v_mfma_f32_16x16x32_bf16 v[124:127], a[184:187], a[24:27], v[124:127]
s_waitcnt lgkmcnt(5)
ds_read_b128 a[8:11], v2 offset:7136
v_fma_f32 v154, v154, s79, v106
v_mfma_f32_16x16x32_bf16 v[124:127], a[196:199], a[28:31], v[124:127]
s_waitcnt lgkmcnt(4)
ds_write_b128 v3, v[116:119] offset:4096
v_pk_fma_f32 v[20:21], v[116:117], s[70:71], v[20:21] op_sel_hi:[1,0,1]
v_pk_fma_f32 v[22:23], v[118:119], s[70:71], v[22:23] op_sel_hi:[1,0,1]
v_mfma_f32_16x16x32_bf16 v[124:127], a[208:211], a[0:3], v[124:127]
global_load_dwordx4 a[128:131], v1, s[48:49] offset:0 sc1
v_fma_f32 v155, v155, s79, v107
v_mfma_f32_16x16x32_bf16 v[128:131], a[212:215], a[0:3], v[128:131]
ds_read_b128 a[12:15], v2 offset:7120
v_fma_f32 v156, v156, s79, v108
v_mfma_f32_16x16x32_bf16 v[128:131], a[200:203], a[28:31], v[128:131]
ds_write_b128 v3, v[112:115] offset:3072
v_pk_fma_f32 v[16:17], v[112:113], s[70:71], v[16:17] op_sel_hi:[1,0,1]
v_pk_fma_f32 v[18:19], v[114:115], s[70:71], v[18:19] op_sel_hi:[1,0,1]
v_mfma_f32_16x16x32_bf16 v[128:131], a[188:191], a[24:27], v[128:131]
global_load_dwordx4 a[132:135], v1, s[48:49] offset:1024 sc1
v_fma_f32 v157, v157, s79, v109
v_mfma_f32_16x16x32_bf16 v[132:135], a[192:195], a[24:27], v[132:135]
ds_read_b128 a[16:19], v2 offset:31232
v_fma_f32 v158, v158, s79, v110
v_mfma_f32_16x16x32_bf16 v[132:135], a[204:207], a[28:31], v[132:135]
ds_write_b128 v3, v[124:127] offset:6144
v_pk_fma_f32 v[28:29], v[124:125], s[70:71], v[28:29] op_sel_hi:[1,0,1]
v_pk_fma_f32 v[30:31], v[126:127], s[70:71], v[30:31] op_sel_hi:[1,0,1]
v_mfma_f32_16x16x32_bf16 v[132:135], a[216:219], a[0:3], v[132:135]
s_waitcnt lgkmcnt(7)
global_load_dwordx4 a[136:139], v1, s[48:49] offset:2048 sc1
v_fma_f32 v159, v159, s79, v111
v_mfma_f32_16x16x32_bf16 v[144:147], a[216:219], a[4:7], v[144:147]
s_waitcnt lgkmcnt(5)
ds_read_b128 a[20:23], v2 offset:31248
v_fma_f32 v168, v168, s79, v120
v_mfma_f32_16x16x32_bf16 v[144:147], a[204:207], a[8:11], v[144:147]
s_waitcnt lgkmcnt(4)
ds_write_b128 v3, v[128:131] offset:7168
v_pk_fma_f32 v[32:33], v[128:129], s[70:71], v[32:33] op_sel_hi:[1,0,1]
v_pk_fma_f32 v[34:35], v[130:131], s[70:71], v[34:35] op_sel_hi:[1,0,1]
v_mfma_f32_16x16x32_bf16 v[144:147], a[192:195], a[12:15], v[144:147]
global_load_dwordx4 a[140:143], v1, s[48:49] offset:3072 sc1
v_add_u32 v1, 0x2000, v1
v_mfma_f32_16x16x32_bf16 v[140:143], a[188:191], a[12:15], v[140:143]
ds_read_b128 a[24:27], v2 offset:31264
v_fma_f32 v169, v169, s79, v121
v_mfma_f32_16x16x32_bf16 v[140:143], a[200:203], a[8:11], v[140:143]
ds_write_b128 v3, v[132:135] offset:8192
v_pk_fma_f32 v[36:37], v[132:133], s[70:71], v[36:37] op_sel_hi:[1,0,1]
v_pk_fma_f32 v[38:39], v[134:135], s[70:71], v[38:39] op_sel_hi:[1,0,1]
v_mfma_f32_16x16x32_bf16 v[140:143], a[212:215], a[4:7], v[140:143]
global_load_dwordx4 a[144:147], v1, s[48:49] offset:-4096 sc1
v_fma_f32 v170, v170, s79, v122
v_mfma_f32_16x16x32_bf16 v[136:139], a[208:211], a[4:7], v[136:139]
ds_read_b128 a[28:31], v2 offset:33200
v_fma_f32 v171, v171, s79, v123
v_mfma_f32_16x16x32_bf16 v[136:139], a[196:199], a[8:11], v[136:139]
ds_write_b128 v3, v[144:147] offset:11264
v_pk_fma_f32 v[48:49], v[144:145], s[70:71], v[48:49] op_sel_hi:[1,0,1]
v_pk_fma_f32 v[50:51], v[146:147], s[70:71], v[50:51] op_sel_hi:[1,0,1]
v_mfma_f32_16x16x32_bf16 v[136:139], a[184:187], a[12:15], v[136:139]
s_waitcnt vmcnt(17) lgkmcnt(7)
global_load_dwordx4 a[148:151], v1, s[48:49] offset:-3072 sc1
v_fma_f32 v164, v164, s79, v116
v_mfma_f32_16x16x32_bf16 v[148:151], a[220:223], a[16:19], v[148:151]
s_waitcnt vmcnt(15) lgkmcnt(5)
ds_read_b128 a[0:3], v2 offset:33184
v_fma_f32 v165, v165, s79, v117
v_mfma_f32_16x16x32_bf16 v[148:151], a[232:235], a[20:23], v[148:151]
s_waitcnt vmcnt(12) lgkmcnt(4)
global_load_dwordx4 a[152:155], v1, s[48:49] offset:-2048 sc1
v_fma_f32 v166, v166, s79, v118
v_mfma_f32_16x16x32_bf16 v[148:151], a[244:247], a[24:27], v[148:151]
s_waitcnt vmcnt(12)
ds_write_b128 v3, v[140:143] offset:10240
v_pk_fma_f32 v[44:45], v[140:141], s[70:71], v[44:45] op_sel_hi:[1,0,1]
v_pk_fma_f32 v[46:47], v[142:143], s[70:71], v[46:47] op_sel_hi:[1,0,1]
v_mfma_f32_16x16x32_bf16 v[152:155], a[248:251], a[24:27], v[152:155]
v_fma_f32 v167, v167, s79, v119
v_fma_f32 v160, v160, s79, v112
v_mfma_f32_16x16x32_bf16 v[152:155], a[236:239], a[20:23], v[152:155]
ds_read_b128 a[4:7], v2 offset:33168
global_load_dwordx4 a[156:159], v1, s[48:49] offset:-1024 sc1
v_mfma_f32_16x16x32_bf16 v[152:155], a[224:227], a[16:19], v[152:155]
ds_write_b128 v3, v[136:139] offset:9216
v_pk_fma_f32 v[40:41], v[136:137], s[70:71], v[40:41] op_sel_hi:[1,0,1]
v_pk_fma_f32 v[42:43], v[138:139], s[70:71], v[42:43] op_sel_hi:[1,0,1]
v_mfma_f32_16x16x32_bf16 v[156:159], a[228:231], a[16:19], v[156:159]
v_fma_f32 v161, v161, s79, v113
v_fma_f32 v162, v162, s79, v114
v_mfma_f32_16x16x32_bf16 v[156:159], a[240:243], a[20:23], v[156:159]
s_waitcnt vmcnt(12)
ds_read_b128 a[8:11], v2 offset:35104
global_load_dwordx4 a[160:163], v1, s[48:49] offset:0 sc1
v_mfma_f32_16x16x32_bf16 v[156:159], a[252:255], a[24:27], v[156:159]
s_waitcnt lgkmcnt(6)
v_fma_f32 v163, v163, s79, v115
v_fma_f32 v172, v172, s79, v124
v_mfma_f32_16x16x32_bf16 v[168:171], a[252:255], a[28:31], v[168:171]
s_waitcnt lgkmcnt(4)
s_waitcnt lgkmcnt(1)
s_barrier
v_mfma_f32_16x16x32_bf16 v[168:171], a[240:243], a[0:3], v[168:171]
ds_read_b128 a[12:15], v2 offset:35120
v_fma_f32 v173, v173, s79, v125
v_mfma_f32_16x16x32_bf16 v[168:171], a[228:231], a[4:7], v[168:171]
global_load_dwordx4 a[164:167], v1, s[48:49] offset:1024 sc1
ds_read_b128 v[200:203], v0 offset:0
v_mfma_f32_16x16x32_bf16 v[164:167], a[224:227], a[4:7], v[164:167]
ds_read_b128 a[16:19], v2 offset:35136
v_fma_f32 v174, v174, s79, v126
v_mfma_f32_16x16x32_bf16 v[164:167], a[236:239], a[0:3], v[164:167]
ds_read_b128 v[204:207], v0 offset:1024
v_fma_f32 v175, v175, s79, v127
v_mfma_f32_16x16x32_bf16 v[164:167], a[248:251], a[28:31], v[164:167]
ds_read_b128 v[208:211], v0 offset:2048
v_fma_f32 v176, v176, s79, v128
v_mfma_f32_16x16x32_bf16 v[160:163], a[244:247], a[28:31], v[160:163]
global_load_dwordx4 a[168:171], v1, s[48:49] offset:2048 sc1
ds_read_b128 a[20:23], v2 offset:37072
v_mfma_f32_16x16x32_bf16 v[160:163], a[232:235], a[0:3], v[160:163]
ds_read_b128 v[212:215], v0 offset:3072
v_fma_f32 v177, v177, s79, v129
v_mfma_f32_16x16x32_bf16 v[160:163], a[220:223], a[4:7], v[160:163]
s_waitcnt lgkmcnt(7)
ds_read_b128 v[216:219], v0 offset:4096
v_fma_f32 v178, v178, s79, v130
v_mfma_f32_16x16x32_bf16 v[172:175], a[220:223], a[8:11], v[172:175]
s_waitcnt lgkmcnt(7)
ds_read_b128 a[24:27], v2 offset:37056
v_fma_f32 v179, v179, s79, v131
v_mfma_f32_16x16x32_bf16 v[172:175], a[232:235], a[12:15], v[172:175]
s_waitcnt lgkmcnt(6)
global_load_dwordx4 a[172:175], v1, s[48:49] offset:3072 sc1
ds_read_b128 v[220:223], v0 offset:5120
v_mfma_f32_16x16x32_bf16 v[172:175], a[244:247], a[16:19], v[172:175]
ds_read_b128 v[224:227], v0 offset:6144
v_add_u32 v1, 0x2000, v1
v_mfma_f32_16x16x32_bf16 v[176:179], a[248:251], a[16:19], v[176:179]
ds_read_b128 a[28:31], v2 offset:37040
v_fma_f32 v180, v180, s79, v132
v_fma_f32 v181, v181, s79, v133
v_fma_f32 v182, v182, s79, v134
v_fma_f32 v183, v183, s79, v135
v_mfma_f32_16x16x32_bf16 v[176:179], a[236:239], a[12:15], v[176:179]
global_load_dwordx4 a[176:179], v1, s[48:49] offset:-4096 sc1
ds_read_b128 v[228:231], v0 offset:7168
v_mfma_f32_16x16x32_bf16 v[176:179], a[224:227], a[8:11], v[176:179]
ds_read_b128 v[232:235], v0 offset:8192
v_fma_f32 v192, v192, s79, v144
v_mfma_f32_16x16x32_bf16 v[180:183], a[228:231], a[8:11], v[180:183]
ds_read_b128 a[0:3], v2 offset:31280
v_fma_f32 v193, v193, s79, v145
v_fma_f32 v194, v194, s79, v146
v_fma_f32 v195, v195, s79, v147
v_mfma_f32_16x16x32_bf16 v[180:183], a[240:243], a[12:15], v[180:183]
ds_read_b128 v[236:239], v0 offset:9216
global_load_dwordx4 a[180:183], v1, s[48:49] offset:-3072 sc1
v_mfma_f32_16x16x32_bf16 v[180:183], a[252:255], a[16:19], v[180:183]
s_waitcnt lgkmcnt(10)
ds_read_b128 v[240:243], v0 offset:10240
v_fma_f32 v188, v188, s79, v140
v_mfma_f32_16x16x32_bf16 v[192:195], a[252:255], a[20:23], v[192:195]
s_waitcnt lgkmcnt(8)
ds_read_b128 a[4:7], v2 offset:31296
v_fma_f32 v189, v189, s79, v141
v_fmac_f32 v4, s79, v200
v_fma_f32 v190, v190, s79, v142
v_fma_f32 v191, v191, s79, v143
v_mfma_f32_16x16x32_bf16 v[192:195], a[240:243], a[24:27], v[192:195]
s_waitcnt lgkmcnt(6)
ds_read_b128 v[244:247], v0 offset:11264
v_fmac_f32 v5, s79, v201
v_fmac_f32 v6, s79, v202
v_fmac_f32 v7, s79, v203
v_cvt_pk_bf16_f32 v52, v4, v5
v_cvt_pk_bf16_f32 v53, v6, v7
v_mfma_f32_16x16x32_bf16 v[192:195], a[228:231], a[28:31], v[192:195]
global_load_dwordx4 a[184:187], v1, s[48:49] offset:-2048 sc1
v_fma_f32 v184, v184, s79, v136
v_mfma_f32_16x16x32_bf16 v[188:191], a[224:227], a[28:31], v[188:191]
ds_write_b64 v198, v[52:53] offset:0
v_fmac_f32 v8, s79, v204
v_fma_f32 v185, v185, s79, v137
v_fma_f32 v186, v186, s79, v138
v_fma_f32 v187, v187, s79, v139
v_mfma_f32_16x16x32_bf16 v[188:191], a[236:239], a[24:27], v[188:191]
ds_read_b128 a[8:11], v2 offset:31872
global_load_dwordx4 a[188:191], v1, s[48:49] offset:-1024 sc1
v_mfma_f32_16x16x32_bf16 v[188:191], a[248:251], a[20:23], v[188:191]
v_fmac_f32 v9, s79, v205
v_fmac_f32 v10, s79, v206
v_mfma_f32_16x16x32_bf16 v[184:187], a[244:247], a[20:23], v[184:187]
ds_read_b128 a[12:15], v2 offset:33808
v_fmac_f32 v11, s79, v207
v_cvt_pk_bf16_f32 v54, v8, v9
v_cvt_pk_bf16_f32 v55, v10, v11
v_mfma_f32_16x16x32_bf16 v[184:187], a[232:235], a[24:27], v[184:187]
global_load_dwordx4 a[192:195], v1, s[48:49] offset:0 sc1
v_fmac_f32 v12, s79, v208
v_mfma_f32_16x16x32_bf16 v[184:187], a[220:223], a[28:31], v[184:187]
s_waitcnt vmcnt(20) lgkmcnt(7)
ds_write_b64 v198, v[54:55] offset:32
v_mfma_f32_16x16x32_bf16 v[148:151], a[112:115], a[0:3], v[148:151]
s_waitcnt vmcnt(17) lgkmcnt(5)
ds_read_b128 a[16:19], v2 offset:33232
v_fmac_f32 v13, s79, v209
v_mfma_f32_16x16x32_bf16 v[148:151], a[124:127], a[4:7], v[148:151]
s_waitcnt vmcnt(14) lgkmcnt(3)
v_fmac_f32 v14, s79, v210
v_fmac_f32 v15, s79, v211
v_cvt_pk_bf16_f32 v56, v12, v13
v_mfma_f32_16x16x32_bf16 v[148:151], a[136:139], a[8:11], v[148:151]
s_waitcnt vmcnt(13)
global_load_dwordx4 a[196:199], v1, s[48:49] offset:1024 sc1
v_cvt_pk_bf16_f32 v57, v14, v15
v_mfma_f32_16x16x32_bf16 v[152:155], a[140:143], a[8:11], v[152:155]
ds_write_b64 v198, v[56:57] offset:64
v_mfma_f32_16x16x32_bf16 v[152:155], a[128:131], a[4:7], v[152:155]
ds_read_b128 a[20:23], v2 offset:33216
v_fmac_f32 v16, s79, v212
v_fmac_f32 v17, s79, v213
v_mfma_f32_16x16x32_bf16 v[152:155], a[116:119], a[0:3], v[152:155]
global_load_dwordx4 a[200:203], v1, s[48:49] offset:2048 sc1
v_fmac_f32 v18, s79, v214
v_mfma_f32_16x16x32_bf16 v[156:159], a[120:123], a[0:3], v[156:159]
ds_read_b128 a[24:27], v2 offset:35152
v_fmac_f32 v19, s79, v215
v_mfma_f32_16x16x32_bf16 v[156:159], a[132:135], a[4:7], v[156:159]
s_waitcnt vmcnt(14)
v_cvt_pk_bf16_f32 v58, v16, v17
v_cvt_pk_bf16_f32 v59, v18, v19
v_fmac_f32 v20, s79, v216
v_mfma_f32_16x16x32_bf16 v[156:159], a[144:147], a[8:11], v[156:159]
s_waitcnt lgkmcnt(5)
ds_write_b64 v198, v[58:59] offset:768
v_mfma_f32_16x16x32_bf16 v[168:171], a[144:147], a[12:15], v[168:171]
s_waitcnt lgkmcnt(4)
global_load_dwordx4 a[204:207], v1, s[48:49] offset:3072 sc1
ds_read_b128 a[28:31], v2 offset:35168
v_mfma_f32_16x16x32_bf16 v[168:171], a[132:135], a[16:19], v[168:171]
s_waitcnt lgkmcnt(3)
v_add_u32 v1, 0x2000, v1
v_fmac_f32 v21, s79, v217
v_mfma_f32_16x16x32_bf16 v[168:171], a[120:123], a[20:23], v[168:171]
v_fmac_f32 v22, s79, v218
v_fmac_f32 v23, s79, v219
v_cvt_pk_bf16_f32 v60, v20, v21
v_mfma_f32_16x16x32_bf16 v[164:167], a[116:119], a[20:23], v[164:167]
ds_read_b128 a[0:3], v2 offset:35744
global_load_dwordx4 a[208:211], v1, s[48:49] offset:-4096 sc1
v_cvt_pk_bf16_f32 v61, v22, v23
v_mfma_f32_16x16x32_bf16 v[164:167], a[128:131], a[16:19], v[164:167]
ds_write_b64 v198, v[60:61] offset:800
v_mfma_f32_16x16x32_bf16 v[164:167], a[140:143], a[12:15], v[164:167]
v_fmac_f32 v24, s79, v220
v_fmac_f32 v25, s79, v221
v_fmac_f32 v26, s79, v222
v_mfma_f32_16x16x32_bf16 v[160:163], a[136:139], a[12:15], v[160:163]
ds_read_b128 a[4:7], v2 offset:37680
global_load_dwordx4 a[212:215], v1, s[48:49] offset:-3072 sc1
v_mfma_f32_16x16x32_bf16 v[160:163], a[124:127], a[16:19], v[160:163]
v_fmac_f32 v27, s79, v223
v_cvt_pk_bf16_f32 v62, v24, v25
v_mfma_f32_16x16x32_bf16 v[160:163], a[112:115], a[20:23], v[160:163]
s_waitcnt lgkmcnt(5)
v_cvt_pk_bf16_f32 v63, v26, v27
v_fmac_f32 v28, s79, v224
v_fmac_f32 v29, s79, v225
v_mfma_f32_16x16x32_bf16 v[172:175], a[112:115], a[24:27], v[172:175]
s_waitcnt lgkmcnt(3)
ds_write_b64 v198, v[62:63] offset:832
v_mfma_f32_16x16x32_bf16 v[172:175], a[124:127], a[28:31], v[172:175]
s_waitcnt lgkmcnt(3)
ds_read_b128 a[8:11], v2 offset:37104
global_load_dwordx4 a[216:219], v1, s[48:49] offset:-2048 sc1
v_mfma_f32_16x16x32_bf16 v[172:175], a[136:139], a[0:3], v[172:175]
v_fmac_f32 v30, s79, v226
v_fmac_f32 v31, s79, v227
v_mfma_f32_16x16x32_bf16 v[176:179], a[140:143], a[0:3], v[176:179]
ds_read_b128 a[12:15], v2 offset:37088
v_cvt_pk_bf16_f32 v64, v28, v29
v_cvt_pk_bf16_f32 v65, v30, v31
v_mfma_f32_16x16x32_bf16 v[176:179], a[128:131], a[28:31], v[176:179]
ds_write_b64 v198, v[64:65] offset:1536
v_mfma_f32_16x16x32_bf16 v[176:179], a[116:119], a[24:27], v[176:179]
global_load_dwordx4 a[220:223], v1, s[48:49] offset:-1024 sc1
v_fmac_f32 v32, s79, v228
v_mfma_f32_16x16x32_bf16 v[180:183], a[120:123], a[24:27], v[180:183]
ds_read_b128 a[16:19], v2 offset:31888
v_fmac_f32 v33, s79, v229
v_fmac_f32 v34, s79, v230
v_mfma_f32_16x16x32_bf16 v[180:183], a[132:135], a[28:31], v[180:183]
v_fmac_f32 v35, s79, v231
v_cvt_pk_bf16_f32 v66, v32, v33
v_mfma_f32_16x16x32_bf16 v[180:183], a[144:147], a[0:3], v[180:183]
s_waitcnt lgkmcnt(5)
global_load_dwordx4 a[224:227], v1, s[48:49] offset:0 sc1
v_cvt_pk_bf16_f32 v67, v34, v35
v_mfma_f32_16x16x32_bf16 v[192:195], a[144:147], a[4:7], v[192:195]
s_waitcnt lgkmcnt(3)
ds_write_b64 v198, v[66:67] offset:1568
v_fmac_f32 v36, s79, v232
v_mfma_f32_16x16x32_bf16 v[192:195], a[132:135], a[8:11], v[192:195]
s_waitcnt lgkmcnt(3)
ds_read_b128 a[20:23], v2 offset:31904
v_fmac_f32 v37, s79, v233
v_mfma_f32_16x16x32_bf16 v[192:195], a[120:123], a[12:15], v[192:195]
v_fmac_f32 v38, s79, v234
v_fmac_f32 v39, s79, v235
v_mfma_f32_16x16x32_bf16 v[188:191], a[116:119], a[12:15], v[188:191]
global_load_dwordx4 a[228:231], v1, s[48:49] offset:1024 sc1
ds_read_b128 a[24:27], v2 offset:31920
v_mfma_f32_16x16x32_bf16 v[188:191], a[128:131], a[8:11], v[188:191]
v_cvt_pk_bf16_f32 v68, v36, v37
v_cvt_pk_bf16_f32 v69, v38, v39
v_fmac_f32 v40, s79, v236
v_mfma_f32_16x16x32_bf16 v[188:191], a[140:143], a[4:7], v[188:191]
ds_write_b64 v198, v[68:69] offset:1600
v_mfma_f32_16x16x32_bf16 v[184:187], a[136:139], a[4:7], v[184:187]
ds_read_b128 a[28:31], v2 offset:33856
global_load_dwordx4 a[232:235], v1, s[48:49] offset:2048 sc1
v_mfma_f32_16x16x32_bf16 v[184:187], a[124:127], a[8:11], v[184:187]
v_fmac_f32 v41, s79, v237
v_fmac_f32 v42, s79, v238
v_fmac_f32 v43, s79, v239
v_mfma_f32_16x16x32_bf16 v[184:187], a[112:115], a[12:15], v[184:187]
s_waitcnt vmcnt(21) lgkmcnt(5)
v_cvt_pk_bf16_f32 v70, v40, v41
v_cvt_pk_bf16_f32 v71, v42, v43
v_mfma_f32_16x16x32_bf16 v[148:151], a[148:151], a[16:19], v[148:151]
s_waitcnt vmcnt(18) lgkmcnt(3)
ds_write_b64 v198, v[70:71] offset:2304
v_mfma_f32_16x16x32_bf16 v[148:151], a[160:163], a[20:23], v[148:151]
s_waitcnt vmcnt(15) lgkmcnt(3)
ds_read_b128 a[0:3], v2 offset:33840
global_load_dwordx4 a[236:239], v1, s[48:49] offset:3072 sc1
v_fmac_f32 v44, s79, v240
v_mfma_f32_16x16x32_bf16 v[148:151], a[172:175], a[24:27], v[148:151]
s_waitcnt vmcnt(15)
v_add_u32 v1, 0x2000, v1
v_fmac_f32 v45, s79, v241
v_mfma_f32_16x16x32_bf16 v[152:155], a[176:179], a[24:27], v[152:155]
ds_read_b128 a[4:7], v2 offset:33824
v_fmac_f32 v46, s79, v242
v_mfma_f32_16x16x32_bf16 v[152:155], a[164:167], a[20:23], v[152:155]
v_fmac_f32 v47, s79, v243
v_cvt_pk_bf16_f32 v72, v44, v45
v_mfma_f32_16x16x32_bf16 v[152:155], a[152:155], a[16:19], v[152:155]
global_load_dwordx4 a[240:243], v1, s[48:49] offset:-4096 sc1
v_cvt_pk_bf16_f32 v73, v46, v47
v_fmac_f32 v48, s79, v244
v_mfma_f32_16x16x32_bf16 v[156:159], a[156:159], a[16:19], v[156:159]
ds_write_b64 v198, v[72:73] offset:2336
v_mfma_f32_16x16x32_bf16 v[156:159], a[168:171], a[20:23], v[156:159]
s_waitcnt vmcnt(15)
ds_read_b128 a[8:11], v2 offset:35760
v_fmac_f32 v49, s79, v245
v_mfma_f32_16x16x32_bf16 v[156:159], a[180:183], a[24:27], v[156:159]
s_waitcnt lgkmcnt(5)
global_load_dwordx4 a[244:247], v1, s[48:49] offset:-3072 sc1
v_fmac_f32 v50, s79, v246
v_fmac_f32 v51, s79, v247
v_mfma_f32_16x16x32_bf16 v[168:171], a[180:183], a[28:31], v[168:171]
s_waitcnt lgkmcnt(3)
L_stub3:
s_cbranch_execz L_body
v_mfma_f32_16x16x32_bf16 v[168:171], a[168:171], a[0:3], v[168:171]
s_waitcnt lgkmcnt(2)
ds_read_b128 a[12:15], v2 offset:35776
v_cvt_pk_bf16_f32 v74, v48, v49
v_mfma_f32_16x16x32_bf16 v[168:171], a[156:159], a[4:7], v[168:171]
v_cvt_pk_bf16_f32 v75, v50, v51
v_fmac_f32 v148, s61, v200
v_mfma_f32_16x16x32_bf16 v[164:167], a[152:155], a[4:7], v[164:167]
global_load_dwordx4 a[248:251], v1, s[48:49] offset:-2048 sc1
ds_read_b128 a[16:19], v2 offset:35792
v_mfma_f32_16x16x32_bf16 v[164:167], a[164:167], a[0:3], v[164:167]
ds_write_b64 v198, v[74:75] offset:2368
v_mfma_f32_16x16x32_bf16 v[164:167], a[176:179], a[28:31], v[164:167]
v_fmac_f32 v149, s61, v201
v_fmac_f32 v150, s61, v202
v_mfma_f32_16x16x32_bf16 v[160:163], a[172:175], a[28:31], v[160:163]
ds_read_b128 a[20:23], v2 offset:37728
global_load_dwordx4 a[252:255], v1, s[48:49] offset:-1024 sc1
v_mfma_f32_16x16x32_bf16 v[160:163], a[160:163], a[0:3], v[160:163]
v_fmac_f32 v151, s61, v203
v_fmac_f32 v152, s61, v204
v_mfma_f32_16x16x32_bf16 v[160:163], a[148:151], a[4:7], v[160:163]
s_waitcnt lgkmcnt(4)
v_fmac_f32 v153, s61, v205
v_fmac_f32 v154, s61, v206
v_mfma_f32_16x16x32_bf16 v[172:175], a[148:151], a[8:11], v[172:175]
s_waitcnt lgkmcnt(3)
s_waitcnt lgkmcnt(1)
s_barrier
v_mfma_f32_16x16x32_bf16 v[172:175], a[160:163], a[12:15], v[172:175]
ds_read_b128 a[24:27], v2 offset:37712
v_fmac_f32 v155, s61, v207
v_mfma_f32_16x16x32_bf16 v[172:175], a[172:175], a[16:19], v[172:175]
ds_read_b128 v[116:119], v199 offset:256
v_fmac_f32 v156, s61, v208
v_mfma_f32_16x16x32_bf16 v[176:179], a[176:179], a[16:19], v[176:179]
ds_read_b128 a[28:31], v2 offset:37696
v_fmac_f32 v157, s61, v209
v_mfma_f32_16x16x32_bf16 v[176:179], a[164:167], a[12:15], v[176:179]
ds_read_b128 v[120:123], v199 offset:1024
v_fmac_f32 v158, s61, v210
v_mfma_f32_16x16x32_bf16 v[176:179], a[152:155], a[8:11], v[176:179]
ds_read_b128 v[124:127], v199 offset:1792
v_fmac_f32 v159, s61, v211
v_mfma_f32_16x16x32_bf16 v[180:183], a[156:159], a[8:11], v[180:183]
ds_read_b128 v[128:131], v199 offset:2560
v_fmac_f32 v168, s61, v220
v_mfma_f32_16x16x32_bf16 v[180:183], a[168:171], a[12:15], v[180:183]
ds_read_b128 a[0:3], v2 offset:31936
v_fmac_f32 v169, s61, v221
v_mfma_f32_16x16x32_bf16 v[180:183], a[180:183], a[16:19], v[180:183]
s_waitcnt lgkmcnt(5)
global_store_dwordx4 v248, v[116:119], s[44:45] offset:256 sc1
v_mfma_f32_16x16x32_bf16 v[192:195], a[180:183], a[20:23], v[192:195]
ds_read_b128 a[4:7], v2 offset:32512
v_fmac_f32 v170, s61, v222
v_mfma_f32_16x16x32_bf16 v[192:195], a[168:171], a[24:27], v[192:195]
s_waitcnt lgkmcnt(4)
global_store_dwordx4 v248, v[120:123], s[44:45] offset:1024 sc1
v_mfma_f32_16x16x32_bf16 v[192:195], a[156:159], a[28:31], v[192:195]
v_fmac_f32 v171, s61, v223
v_fmac_f32 v164, s61, v216
v_mfma_f32_16x16x32_bf16 v[188:191], a[152:155], a[28:31], v[188:191]
ds_read_b128 a[8:11], v2 offset:32528
v_fmac_f32 v165, s61, v217
v_mfma_f32_16x16x32_bf16 v[188:191], a[164:167], a[24:27], v[188:191]
v_fmac_f32 v166, s61, v218
v_fmac_f32 v167, s61, v219
v_mfma_f32_16x16x32_bf16 v[188:191], a[176:179], a[20:23], v[188:191]
s_waitcnt lgkmcnt(4)
global_store_dwordx4 v248, v[124:127], s[44:45] offset:1792 sc1
v_mfma_f32_16x16x32_bf16 v[184:187], a[172:175], a[20:23], v[184:187]
ds_read_b128 a[12:15], v2 offset:32544
v_fmac_f32 v160, s61, v212
v_mfma_f32_16x16x32_bf16 v[184:187], a[160:163], a[24:27], v[184:187]
v_fmac_f32 v161, s61, v213
v_fmac_f32 v162, s61, v214
v_mfma_f32_16x16x32_bf16 v[184:187], a[148:151], a[28:31], v[184:187]
s_waitcnt vmcnt(20) lgkmcnt(3)
v_fmac_f32 v163, s61, v215
v_fmac_f32 v180, s61, v232
v_mfma_f32_16x16x32_bf16 v[148:151], a[184:187], a[0:3], v[148:151]
s_waitcnt vmcnt(17) lgkmcnt(2)
ds_read_b128 a[16:19], v2 offset:32560
v_fmac_f32 v181, s61, v233
v_mfma_f32_16x16x32_bf16 v[148:151], a[196:199], a[4:7], v[148:151]
s_waitcnt vmcnt(14) lgkmcnt(2)
global_store_dwordx4 v248, v[128:131], s[44:45] offset:2560 sc1
v_mfma_f32_16x16x32_bf16 v[148:151], a[208:211], a[8:11], v[148:151]
s_waitcnt vmcnt(14)
v_fmac_f32 v182, s61, v234
v_fmac_f32 v183, s61, v235
v_mfma_f32_16x16x32_bf16 v[152:155], a[212:215], a[8:11], v[152:155]
ds_read_b128 a[20:23], v2 offset:32576
v_fmac_f32 v176, s61, v228
v_mfma_f32_16x16x32_bf16 v[152:155], a[200:203], a[4:7], v[152:155]
v_fmac_f32 v177, s61, v229
v_fmac_f32 v178, s61, v230
v_mfma_f32_16x16x32_bf16 v[152:155], a[188:191], a[0:3], v[152:155]
v_fmac_f32 v179, s61, v231
v_fmac_f32 v172, s61, v224
v_mfma_f32_16x16x32_bf16 v[156:159], a[192:195], a[0:3], v[156:159]
ds_read_b128 a[24:27], v2 offset:34464
v_fmac_f32 v173, s61, v225
v_mfma_f32_16x16x32_bf16 v[156:159], a[204:207], a[4:7], v[156:159]
s_waitcnt vmcnt(13)
v_fmac_f32 v174, s61, v226
v_fmac_f32 v175, s61, v227
v_mfma_f32_16x16x32_bf16 v[156:159], a[216:219], a[8:11], v[156:159]
s_waitcnt vmcnt(12) lgkmcnt(3)
v_fmac_f32 v192, s61, v244
v_fmac_f32 v193, s61, v245
v_mfma_f32_16x16x32_bf16 v[148:151], a[220:223], a[12:15], v[148:151]
s_waitcnt vmcnt(9) lgkmcnt(2)
ds_read_b128 a[28:31], v2 offset:34448
v_fmac_f32 v194, s61, v246
v_mfma_f32_16x16x32_bf16 v[148:151], a[232:235], a[16:19], v[148:151]
s_waitcnt vmcnt(6) lgkmcnt(2)
v_fmac_f32 v195, s61, v247
v_fmac_f32 v188, s61, v240
v_mfma_f32_16x16x32_bf16 v[148:151], a[244:247], a[20:23], v[148:151]
s_waitcnt vmcnt(5)
v_fmac_f32 v189, s61, v241
v_fmac_f32 v190, s61, v242
v_mfma_f32_16x16x32_bf16 v[152:155], a[248:251], a[20:23], v[152:155]
ds_read_b128 a[0:3], v2 offset:33872
v_fmac_f32 v191, s61, v243
v_mfma_f32_16x16x32_bf16 v[152:155], a[236:239], a[16:19], v[152:155]
v_fmac_f32 v184, s61, v236
v_cvt_pk_bf16_f32 v132, v148, v149
v_mfma_f32_16x16x32_bf16 v[152:155], a[224:227], a[12:15], v[152:155]
v_cvt_pk_bf16_f32 v133, v150, v151
v_fmac_f32 v185, s61, v237
v_mfma_f32_16x16x32_bf16 v[156:159], a[228:231], a[12:15], v[156:159]
ds_read_b128 a[4:7], v2 offset:34480
v_fmac_f32 v186, s61, v238
v_mfma_f32_16x16x32_bf16 v[156:159], a[240:243], a[16:19], v[156:159]
s_waitcnt vmcnt(4)
ds_write_b64 v197, v[132:133] offset:0
v_mfma_f32_16x16x32_bf16 v[156:159], a[252:255], a[20:23], v[156:159]
s_waitcnt lgkmcnt(4)
v_cvt_pk_bf16_f32 v134, v152, v153
v_cvt_pk_bf16_f32 v135, v154, v155
v_mfma_f32_16x16x32_bf16 v[168:171], a[216:219], a[24:27], v[168:171]
s_waitcnt lgkmcnt(3)
ds_read_b128 a[8:11], v2 offset:34496
v_fmac_f32 v187, s61, v239
v_mfma_f32_16x16x32_bf16 v[168:171], a[204:207], a[28:31], v[168:171]
s_waitcnt lgkmcnt(3)
ds_write_b64 v197, v[134:135] offset:32
v_mfma_f32_16x16x32_bf16 v[168:171], a[192:195], a[0:3], v[168:171]
v_cvt_pk_bf16_f32 v136, v156, v157
v_cvt_pk_bf16_f32 v137, v158, v159
v_mfma_f32_16x16x32_bf16 v[164:167], a[188:191], a[0:3], v[164:167]
ds_read_b128 a[12:15], v2 offset:34512
v_mfma_f32_16x16x32_bf16 v[164:167], a[200:203], a[28:31], v[164:167]
ds_write_b64 v197, v[136:137] offset:64
v_mfma_f32_16x16x32_bf16 v[164:167], a[212:215], a[24:27], v[164:167]
v_mfma_f32_16x16x32_bf16 v[160:163], a[208:211], a[24:27], v[160:163]
ds_read_b128 a[16:19], v2 offset:36400
v_mfma_f32_16x16x32_bf16 v[160:163], a[196:199], a[28:31], v[160:163]
v_mfma_f32_16x16x32_bf16 v[160:163], a[184:187], a[0:3], v[160:163]
s_waitcnt lgkmcnt(6)
v_mfma_f32_16x16x32_bf16 v[160:163], a[220:223], a[4:7], v[160:163]
s_waitcnt lgkmcnt(4)
ds_read_b128 a[20:23], v2 offset:36384
v_mfma_f32_16x16x32_bf16 v[160:163], a[232:235], a[8:11], v[160:163]
s_waitcnt lgkmcnt(3)
v_mfma_f32_16x16x32_bf16 v[160:163], a[244:247], a[12:15], v[160:163]
s_nop 2
v_mfma_f32_16x16x32_bf16 v[164:167], a[248:251], a[12:15], v[164:167]
s_waitcnt lgkmcnt(2)
s_barrier
ds_read_b128 a[24:27], v2 offset:35808
v_mfma_f32_16x16x32_bf16 v[164:167], a[236:239], a[8:11], v[164:167]
ds_read_b128 v[100:103], v199 offset:0
v_cvt_pk_bf16_f32 v138, v160, v161
v_mfma_f32_16x16x32_bf16 v[164:167], a[224:227], a[4:7], v[164:167]
ds_read_b128 v[104:107], v199 offset:512
v_cvt_pk_bf16_f32 v139, v162, v163
v_mfma_f32_16x16x32_bf16 v[168:171], a[228:231], a[4:7], v[168:171]
ds_read_b128 a[28:31], v2 offset:36416
v_mfma_f32_16x16x32_bf16 v[168:171], a[240:243], a[8:11], v[168:171]
ds_write_b64 v197, v[138:139] offset:768
v_mfma_f32_16x16x32_bf16 v[168:171], a[252:255], a[12:15], v[168:171]
s_waitcnt lgkmcnt(6)
v_cvt_pk_bf16_f32 v140, v164, v165
v_cvt_pk_bf16_f32 v141, v166, v167
v_mfma_f32_16x16x32_bf16 v[180:183], a[216:219], a[16:19], v[180:183]
s_waitcnt lgkmcnt(5)
ds_read_b128 a[0:3], v2 offset:36432
v_mfma_f32_16x16x32_bf16 v[180:183], a[204:207], a[20:23], v[180:183]
s_waitcnt lgkmcnt(4)
global_store_dwordx4 v248, v[100:103], s[44:45] offset:0 sc1
v_mfma_f32_16x16x32_bf16 v[180:183], a[192:195], a[24:27], v[180:183]
ds_write_b64 v197, v[140:141] offset:800
v_mfma_f32_16x16x32_bf16 v[176:179], a[188:191], a[24:27], v[176:179]
ds_read_b128 a[4:7], v2 offset:36448
v_cvt_pk_bf16_f32 v142, v168, v169
v_mfma_f32_16x16x32_bf16 v[176:179], a[200:203], a[20:23], v[176:179]
s_waitcnt lgkmcnt(5)
global_store_dwordx4 v248, v[104:107], s[44:45] offset:512 sc1
v_mfma_f32_16x16x32_bf16 v[176:179], a[212:215], a[16:19], v[176:179]
v_cvt_pk_bf16_f32 v143, v170, v171
v_mfma_f32_16x16x32_bf16 v[172:175], a[208:211], a[16:19], v[172:175]
ds_write_b64 v197, v[142:143] offset:832
v_mfma_f32_16x16x32_bf16 v[172:175], a[196:199], a[20:23], v[172:175]
ds_read_b128 a[8:11], v2 offset:38336
v_mfma_f32_16x16x32_bf16 v[172:175], a[184:187], a[24:27], v[172:175]
s_waitcnt lgkmcnt(6)
v_mfma_f32_16x16x32_bf16 v[172:175], a[220:223], a[28:31], v[172:175]
s_waitcnt lgkmcnt(4)
ds_read_b128 a[12:15], v2 offset:38320
v_mfma_f32_16x16x32_bf16 v[172:175], a[232:235], a[0:3], v[172:175]
s_waitcnt lgkmcnt(3)
v_mfma_f32_16x16x32_bf16 v[172:175], a[244:247], a[4:7], v[172:175]
s_nop 2
v_mfma_f32_16x16x32_bf16 v[176:179], a[248:251], a[4:7], v[176:179]
s_waitcnt lgkmcnt(2)
s_barrier
ds_read_b128 a[16:19], v2 offset:37744
v_mfma_f32_16x16x32_bf16 v[176:179], a[236:239], a[0:3], v[176:179]
ds_read_b128 v[116:119], v199 offset:768
v_cvt_pk_bf16_f32 v132, v172, v173
v_mfma_f32_16x16x32_bf16 v[176:179], a[224:227], a[28:31], v[176:179]
ds_read_b128 v[120:123], v199 offset:1280
v_cvt_pk_bf16_f32 v133, v174, v175
v_mfma_f32_16x16x32_bf16 v[180:183], a[228:231], a[28:31], v[180:183]
ds_read_b128 a[20:23], v2 offset:38352
v_mfma_f32_16x16x32_bf16 v[180:183], a[240:243], a[0:3], v[180:183]
ds_write_b64 v197, v[132:133] offset:1536
v_mfma_f32_16x16x32_bf16 v[180:183], a[252:255], a[4:7], v[180:183]
s_waitcnt lgkmcnt(6)
v_cvt_pk_bf16_f32 v134, v176, v177
v_cvt_pk_bf16_f32 v135, v178, v179
v_mfma_f32_16x16x32_bf16 v[192:195], a[216:219], a[8:11], v[192:195]
s_waitcnt lgkmcnt(5)
ds_read_b128 a[24:27], v2 offset:38368
v_mfma_f32_16x16x32_bf16 v[192:195], a[204:207], a[12:15], v[192:195]
s_waitcnt lgkmcnt(4)
global_store_dwordx4 v248, v[116:119], s[44:45] offset:768 sc1
v_mfma_f32_16x16x32_bf16 v[192:195], a[192:195], a[16:19], v[192:195]
ds_write_b64 v197, v[134:135] offset:1568
v_mfma_f32_16x16x32_bf16 v[188:191], a[188:191], a[16:19], v[188:191]
ds_read_b128 a[28:31], v2 offset:38384
v_cvt_pk_bf16_f32 v136, v180, v181
v_mfma_f32_16x16x32_bf16 v[188:191], a[200:203], a[12:15], v[188:191]
s_waitcnt lgkmcnt(5)
global_store_dwordx4 v248, v[120:123], s[44:45] offset:1280 sc1
v_mfma_f32_16x16x32_bf16 v[188:191], a[212:215], a[8:11], v[188:191]
v_cvt_pk_bf16_f32 v137, v182, v183
ds_write_b64 v197, v[136:137] offset:1600
v_mfma_f32_16x16x32_bf16 v[184:187], a[208:211], a[8:11], v[184:187]
v_mfma_f32_16x16x32_bf16 v[184:187], a[196:199], a[12:15], v[184:187]
v_mfma_f32_16x16x32_bf16 v[184:187], a[184:187], a[16:19], v[184:187]
s_waitcnt lgkmcnt(5)
v_mfma_f32_16x16x32_bf16 v[184:187], a[220:223], a[20:23], v[184:187]
s_waitcnt lgkmcnt(3)
s_waitcnt lgkmcnt(0)
s_barrier
v_mfma_f32_16x16x32_bf16 v[184:187], a[232:235], a[24:27], v[184:187]
ds_read_b128 v[100:103], v199 offset:1536
v_mfma_f32_16x16x32_bf16 v[184:187], a[244:247], a[28:31], v[184:187]
ds_read_b128 v[104:107], v199 offset:2048
s_nop 0
v_mfma_f32_16x16x32_bf16 v[188:191], a[248:251], a[28:31], v[188:191]
s_nop 2
v_mfma_f32_16x16x32_bf16 v[188:191], a[236:239], a[24:27], v[188:191]
v_mfma_f32_16x16x32_bf16 v[188:191], a[224:227], a[20:23], v[188:191]
v_cvt_pk_bf16_f32 v138, v184, v185
v_cvt_pk_bf16_f32 v139, v186, v187
v_mfma_f32_16x16x32_bf16 v[192:195], a[228:231], a[20:23], v[192:195]
s_waitcnt lgkmcnt(1)
global_store_dwordx4 v248, v[100:103], s[44:45] offset:1536 sc1
v_mfma_f32_16x16x32_bf16 v[192:195], a[240:243], a[24:27], v[192:195]
ds_write_b64 v197, v[138:139] offset:2304
v_mfma_f32_16x16x32_bf16 v[192:195], a[252:255], a[28:31], v[192:195]
s_waitcnt lgkmcnt(1)
global_store_dwordx4 v248, v[104:107], s[44:45] offset:2048 sc1
v_cvt_pk_bf16_f32 v140, v188, v189
v_cvt_pk_bf16_f32 v141, v190, v191
ds_write_b64 v197, v[140:141] offset:2336
s_nop 2
v_cvt_pk_bf16_f32 v142, v192, v193
v_cvt_pk_bf16_f32 v143, v194, v195
ds_write_b64 v197, v[142:143] offset:2368
s_waitcnt lgkmcnt(0)
s_barrier
ds_read_b128 v[116:119], v199 offset:2304
ds_read_b128 v[120:123], v199 offset:2816
s_waitcnt lgkmcnt(1)
global_store_dwordx4 v248, v[116:119], s[44:45] offset:2304 sc1
s_waitcnt lgkmcnt(0)
global_store_dwordx4 v248, v[120:123], s[44:45] offset:2816 sc1
s_endpgm
L_late:
s_mov_b32 s66, 0
L_spin1:
s_nop 4
s_cbranch_vccz L_sp1
global_load_dwordx2 v[132:133], v69, s[46:47] offset:0 sc1
L_sp1:
global_load_dwordx2 v[134:135], v70, s[48:49] offset:0 sc1
s_add_u32 s66, s66, 1
s_waitcnt vmcnt(0)
v_cmp_ne_u64 s[82:83], v[132:133], v[134:135]
v_cmp_eq_u32 vcc, 0, v132
s_cmp_ge_u32 s66, 0x10000
s_cbranch_scc1 L_go
s_or_b64 s[82:83], s[82:83], vcc
s_cbranch_scc1 L_spin1
s_branch L_go
L_late2:
s_mov_b32 s66, 0
L_spin2:
global_load_dword v134, v69, s[46:47] offset:160 sc1
s_add_u32 s66, s66, 1
s_waitcnt vmcnt(0)
v_cmp_eq_u32 vcc, 0, v134
s_cmp_ge_u32 s66, 0x10000
s_cbranch_scc1 L_go2
s_cmp_lg_u64 vcc, 0
s_cbranch_scc1 L_spin2
s_branch L_go2
L_end:
.section .rodata,"a"
.p2align 6
.amdhsa_kernel standalone__detection_seg_fpn_lateral__vision_kernel
  .amdhsa_next_free_vgpr 512
  .amdhsa_next_free_sgpr 102
  .amdhsa_accum_offset 256
  .amdhsa_group_segment_fixed_size 0
  .amdhsa_kernarg_size 56
  .amdhsa_user_sgpr_count 2
  .amdhsa_user_sgpr_kernarg_segment_ptr 1
  .amdhsa_system_sgpr_workgroup_id_x 1
  .amdhsa_float_denorm_mode_32 3
.end_amdhsa_kernel
```
